```python
import torch

def _softmax(x, axis=-1):
    return torch.softmax(x, dim=axis)
def _gelu(x):
    return torch.nn.functional.gelu(x, approximate="tanh")
def _silu(x):
    return torch.nn.functional.silu(x)
def _sigmoid(x):
    return torch.sigmoid(x)
def _layernorm(x, axis=-1, eps=1e-5):
    m = x.mean(dim=axis, keepdim=True)
    v = x.var(dim=axis, keepdim=True, unbiased=False)
    return (x - m) / torch.sqrt(v + eps)
def _scatter_add(tgt, idx, src, axis=0):
    return tgt.clone().index_add_(axis, idx, src)
def _segment_sum(src, seg, n):
    out = torch.zeros((n,) + src.shape[1:], dtype=src.dtype)
    return out.index_add_(0, seg, src)
def _pad(x, pw):
    flat = tuple(v for pair in reversed(pw) for v in pair)
    return torch.nn.functional.pad(x, flat)

kernel_name = 'parallel_sum__grouped_kv_mqa__dense_activation_squared_relu__prompt'

def setup_inputs():

    _w = (lambda a: (lambda t: t.to(torch.bfloat16) if t.is_floating_point() else t)(torch.as_tensor(a)))
    def _A_setup():
        B, S, D, H = 1, 2048, 640, 32
        Dh = D // H
        return {
            "x": _w((lambda *s: torch.randn(*s, dtype=torch.bfloat16) * 0.05)(B, S, D)),
            "wq": _w((lambda *s: torch.randn(*s, dtype=torch.bfloat16) * 0.2)(D, H * Dh)),
            "wk": _w((lambda *s: torch.randn(*s, dtype=torch.bfloat16) * 0.2)(D, Dh)),
            "wv": _w((lambda *s: torch.randn(*s, dtype=torch.bfloat16) * 0.1)(D, Dh)),
            "wo": _w((lambda *s: torch.randn(*s, dtype=torch.bfloat16) * 0.1)(H * Dh, D)),
        }
    _A_in = _A_setup()

    def _B_setup():
        B, S, D, F = 1, 2048, 640, 1728
        return {
            "x": _w((lambda *s: torch.randn(*s, dtype=torch.bfloat16) * 0.05)(B, S, D)),
            "w1": _w((lambda *s: torch.randn(*s, dtype=torch.bfloat16) * 0.1)(D, F)),
            "b1": _w((lambda *s: torch.randn(*s, dtype=torch.bfloat16) * 0.4)(F)),
            "w2": _w((lambda *s: torch.randn(*s, dtype=torch.bfloat16) * 0.1)(F, D)),
            "b2": _w((lambda *s: torch.randn(*s, dtype=torch.bfloat16) * 12.8)(D)),
        }
    _B_in = _B_setup()

    return {
        "A_x": _A_in["x"],
        "A_wq": _A_in["wq"],
        "A_wk": _A_in["wk"],
        "A_wv": _A_in["wv"],
        "A_wo": _A_in["wo"],
        "B_x": _B_in["x"],
        "B_w1": _B_in["w1"],
        "B_b1": _B_in["b1"],
        "B_w2": _B_in["w2"],
        "B_b2": _B_in["b2"],
    }

def reference(A_x, A_wq, A_wk, A_wv, A_wo, B_x, B_w1, B_b1, B_w2, B_b2):
    def _A_ref(x, wq, wk, wv, wo):
        B, S, D = x.shape
        H = 32
        Dh = D // H
        q = (lambda x, *d: x.permute(*d))((x @ wq).reshape(B, S, H, Dh), 0, 2, 1, 3)
        k = x @ wk
        v = x @ wv
        scores = torch.einsum("bhqd,bkd->bhqk", q, k) * (Dh ** -0.5)
        p = _softmax(scores, axis=-1)
        o = torch.einsum("bhqk,bkd->bhqd", p, v)
        return (lambda x, *d: x.permute(*d))(o, 0, 2, 1, 3).reshape(B, S, H * Dh) @ wo

    def _B_ref(x, w1, b1, w2, b2):
        h = torch.einsum("bsd,df->bsf", x, w1) + b1
        zero = torch.zeros_like(h)
        r = torch.where(h > zero, h, zero)
        h = r * r
        out = torch.einsum("bsf,fd->bsd", h, w2) + b2
        return out

    x = A_x
    xn = _layernorm(x, axis=-1)
    return x + _A_ref(xn, A_wq, A_wk, A_wv, A_wo) + _B_ref(xn, B_w1, B_b1, B_w2, B_b2)
```

```asm
; @launch kernel=gemm1_kernel grid=(256,1,1) block=(512,1,1) lds=163840
; @launch kernel=k2_kernel grid=(256,1,1) block=(768,1,1) lds=162816
.amdgcn_target "amdgcn-amd-amdhsa--gfx950"
.text
.globl gemm1_kernel
.p2align 8
.type gemm1_kernel,@function
gemm1_kernel:
  s_cmp_ge_u32 s2, 256
  s_cbranch_scc1 L_gemm1_kernel_end
  s_load_dwordx8 s[44:51], s[0:1], 0
  s_getpc_b64 s[94:95]
L_gemm1_kernel_pc:
  v_lshlrev_b32 v2, 7, v0
  v_min_u32 v2, L_code_end-L_gemm1_kernel_pc-4, v2
  global_load_dword v155, v2, s[94:95]
  s_load_dwordx4 s[56:59], s[0:1], 48
  s_load_dwordx2 s[52:53], s[0:1], 32
  s_load_dwordx2 s[54:55], s[0:1], 64
  s_load_dwordx4 s[4:7], s[0:1], 88
  v_lshrrev_b32 v2, 6, v0
  v_and_b32 v1, 63, v0
  s_and_b32 s26, s2, 7
  s_lshr_b32 s27, s2, 3
  v_readfirstlane_b32 s12, v2
  s_lshr_b32 s3, s26, 1
  s_lshl_b32 s3, s3, 2
  s_lshr_b32 s62, s27, 3
  s_add_u32 s13, s62, s3
  s_and_b32 s3, s26, 1
  s_lshl_b32 s3, s3, 3
  s_and_b32 s63, s27, 7
  s_add_u32 s14, s63, s3
  s_and_b32 s15, s12, 3
  s_mov_b32 s24, 0
  s_mov_b32 s25, -1
  s_mov_b32 s22, 0
  s_mov_b32 s34, 0x21c000
  s_mov_b32 s35, 0x00020000
  s_mov_b32 s16, 3456
  s_cmp_lt_u32 s14, 4
  s_cselect_b32 s34, 0xc8000, s34
  s_cselect_b32 s16, 1280, s16
  s_cselect_b32 s3, 0, 4
  s_sub_u32 s3, s14, s3
  s_mul_i32 s17, s3, 320
  s_lshl_b32 s23, s16, 6
  s_mul_i32 s18, s13, 163840
  s_cmp_lt_u32 s12, 4
  s_cbranch_scc1 L_gemm1_kernel_compute
L_gemm1_kernel_loader:
  v_lshrrev_b32 v2, 3, v1
  v_and_b32 v3, 7, v1
  v_lshrrev_b32 v4, 4, v1
  v_xor_b32 v3, v3, v4
  s_lshl_b32 s3, s15, 5
  v_add_u32 v2, s3, v2
  v_mul_u32_u24 v2, 1280, v2
  v_xor_b32 v4, 0, v3
  v_lshl_add_u32 v4, v4, 4, v2
  v_add_u32 v16, 0, v4
  v_xor_b32 v4, 4, v3
  v_lshl_add_u32 v4, v4, 4, v2
  v_add_u32 v17, 9216, v4
  v_xor_b32 v4, 0, v3
  v_lshl_add_u32 v4, v4, 4, v2
  v_add_u32 v18, 18432, v4
  v_xor_b32 v4, 4, v3
  v_lshl_add_u32 v4, v4, 4, v2
  v_add_u32 v19, 27648, v4
  s_mul_i32 s61, s62, 5
  s_add_u32 s61, s61, 1
  s_lshr_b32 s61, s61, 1
  s_mov_b32 s61, 0
  s_sub_u32 s3, s61, 10
  s_cmp_ge_u32 s61, 10
  s_cselect_b32 s61, s3, s61
  s_cmp_eq_u32 s14, 15
  s_cselect_b32 s61, 0, s61
  s_lshl_b32 s3, s61, 7
  s_add_u32 s18, s18, s3
  s_mul_i32 s19, s61, s23
  s_add_u32 s19, s19, s17
  s_mul_i32 s60, s23, 10
  s_lshl_b32 s20, s15, 12
  s_mul_i32 s21, s15, 5120
  s_add_u32 s21, s21, 65536
  s_lshl_b32 s3, s15, 4
  v_add_u32 v2, 0, v1
  v_mul_u32_u24 v3, 3277, v2
  v_lshrrev_b32 v3, 16, v3
  v_mul_u32_u24 v4, 20, v3
  v_sub_u32 v4, v2, v4
  v_add_u32 v3, s3, v3
  v_mul_lo_u32 v3, v3, s16
  v_lshl_add_u32 v3, v4, 4, v3
  v_subrev_u32 v20, 0, v3
  v_add_u32 v2, 64, v1
  v_mul_u32_u24 v3, 3277, v2
  v_lshrrev_b32 v3, 16, v3
  v_mul_u32_u24 v4, 20, v3
  v_sub_u32 v4, v2, v4
  v_add_u32 v3, s3, v3
  v_mul_lo_u32 v3, v3, s16
  v_lshl_add_u32 v3, v4, 4, v3
  v_subrev_u32 v21, 1024, v3
  v_add_u32 v2, 128, v1
  v_mul_u32_u24 v3, 3277, v2
  v_lshrrev_b32 v3, 16, v3
  v_mul_u32_u24 v4, 20, v3
  v_sub_u32 v4, v2, v4
  v_add_u32 v3, s3, v3
  v_mul_lo_u32 v3, v3, s16
  v_lshl_add_u32 v3, v4, 4, v3
  v_subrev_u32 v22, 2048, v3
  v_add_u32 v2, 192, v1
  v_mul_u32_u24 v3, 3277, v2
  v_lshrrev_b32 v3, 16, v3
  v_mul_u32_u24 v4, 20, v3
  v_sub_u32 v4, v2, v4
  v_add_u32 v3, s3, v3
  v_mul_lo_u32 v3, v3, s16
  v_lshl_add_u32 v3, v4, 4, v3
  v_subrev_u32 v23, 3072, v3
  v_add_u32 v2, 256, v1
  v_mul_u32_u24 v3, 3277, v2
  v_lshrrev_b32 v3, 16, v3
  v_mul_u32_u24 v4, 20, v3
  v_sub_u32 v4, v2, v4
  v_add_u32 v3, s3, v3
  v_mul_lo_u32 v3, v3, s16
  v_lshl_add_u32 v3, v4, 4, v3
  v_subrev_u32 v24, 0, v3
  s_cmp_lt_u32 s14, 4
  s_waitcnt lgkmcnt(0)
  s_cselect_b32 s32, s46, s56
  s_cselect_b32 s33, s47, s57
  s_cmp_lt_u32 s15, 2
  s_cselect_b32 s26, s48, s50
  s_cselect_b32 s27, s49, s51
  s_cmp_eq_u32 s14, 15
  s_cselect_b32 s32, s26, s32
  s_cselect_b32 s33, s27, s33
  s_cselect_b32 s34, 25600, s34
  s_mov_b32 s28, s44
  s_mov_b32 s29, s45
  s_mov_b32 s30, 0x280000
  s_mov_b32 s31, 0x00020000
  s_mov_b32 s8, s6
  s_mov_b32 s9, s7
  s_mov_b32 s10, 0x1000000
  s_mov_b32 s11, 0x00020000
  s_mov_b32 s64, s4
  s_mov_b32 s65, s5
  s_mov_b32 s66, 0x100
  s_mov_b32 s67, 0x00020000
  s_cmp_eq_u32 s14, 15
  s_cbranch_scc1 L_gemm1_kernel_lkv
  s_mov_b32 m0, s20
  s_add_u32 s20, s20, 16384
  buffer_load_dwordx4 v16, s[28:31], s18 offen lds
  buffer_load_dwordx4 v17, s[28:31], s18 offen offset:1024 lds
  buffer_load_dwordx4 v18, s[28:31], s18 offen offset:2048 lds
  buffer_load_dwordx4 v19, s[28:31], s18 offen offset:3072 lds
  s_and_b32 s20, s20, 65535
  s_add_u32 s18, s18, 128
  s_mov_b32 m0, s21
  s_add_u32 s3, s21, 4096
  buffer_load_dwordx4 v20, s[32:35], s19 offen lds
  buffer_load_dwordx4 v21, s[32:35], s19 offen offset:1024 lds
  buffer_load_dwordx4 v22, s[32:35], s19 offen offset:2048 lds
  buffer_load_dwordx4 v23, s[32:35], s19 offen offset:3072 lds
  s_mov_b32 m0, s3
  s_add_u32 s21, s21, 20480
  buffer_load_dwordx4 v24, s[32:35], s19 offen lds
  s_sub_u32 s3, s21, 81920
  s_cmp_ge_u32 s21, 147456
  s_cselect_b32 s21, s3, s21
  s_add_u32 s19, s19, s23
  s_add_u32 s61, s61, 1
  s_cmp_eq_u32 s61, 10
  s_cselect_b32 s3, 1280, 0
  s_cselect_b32 s26, s60, 0
  s_sub_u32 s18, s18, s3
  s_sub_u32 s19, s19, s26
  s_mov_b32 m0, s20
  s_add_u32 s20, s20, 16384
  buffer_load_dwordx4 v16, s[28:31], s18 offen lds
  buffer_load_dwordx4 v17, s[28:31], s18 offen offset:1024 lds
  buffer_load_dwordx4 v18, s[28:31], s18 offen offset:2048 lds
  buffer_load_dwordx4 v19, s[28:31], s18 offen offset:3072 lds
  s_and_b32 s20, s20, 65535
  s_add_u32 s18, s18, 128
  s_mov_b32 m0, s21
  s_add_u32 s3, s21, 4096
  buffer_load_dwordx4 v20, s[32:35], s19 offen lds
  buffer_load_dwordx4 v21, s[32:35], s19 offen offset:1024 lds
  buffer_load_dwordx4 v22, s[32:35], s19 offen offset:2048 lds
  buffer_load_dwordx4 v23, s[32:35], s19 offen offset:3072 lds
  s_mov_b32 m0, s3
  s_add_u32 s21, s21, 20480
  buffer_load_dwordx4 v24, s[32:35], s19 offen lds
  s_sub_u32 s3, s21, 81920
  s_cmp_ge_u32 s21, 147456
  s_cselect_b32 s21, s3, s21
  s_add_u32 s19, s19, s23
  s_add_u32 s61, s61, 1
  s_cmp_eq_u32 s61, 10
  s_cselect_b32 s3, 1280, 0
  s_cselect_b32 s26, s60, 0
  s_sub_u32 s18, s18, s3
  s_sub_u32 s19, s19, s26
  s_mov_b32 m0, s20
  s_add_u32 s20, s20, 16384
  buffer_load_dwordx4 v16, s[28:31], s18 offen lds
  buffer_load_dwordx4 v17, s[28:31], s18 offen offset:1024 lds
  buffer_load_dwordx4 v18, s[28:31], s18 offen offset:2048 lds
  buffer_load_dwordx4 v19, s[28:31], s18 offen offset:3072 lds
  s_and_b32 s20, s20, 65535
  s_add_u32 s18, s18, 128
  s_mov_b32 m0, s21
  s_add_u32 s3, s21, 4096
  buffer_load_dwordx4 v20, s[32:35], s19 offen lds
  buffer_load_dwordx4 v21, s[32:35], s19 offen offset:1024 lds
  buffer_load_dwordx4 v22, s[32:35], s19 offen offset:2048 lds
  buffer_load_dwordx4 v23, s[32:35], s19 offen offset:3072 lds
  s_mov_b32 m0, s3
  s_add_u32 s21, s21, 20480
  buffer_load_dwordx4 v24, s[32:35], s19 offen lds
  s_sub_u32 s3, s21, 81920
  s_cmp_ge_u32 s21, 147456
  s_cselect_b32 s21, s3, s21
  s_add_u32 s19, s19, s23
  s_add_u32 s61, s61, 1
  s_cmp_eq_u32 s61, 10
  s_cselect_b32 s3, 1280, 0
  s_cselect_b32 s26, s60, 0
  s_sub_u32 s18, s18, s3
  s_sub_u32 s19, s19, s26
  s_waitcnt vmcnt(18)
  s_barrier
  s_cmp_eq_u32 s15, 0
  s_cselect_b32 s62, 99, 3
  s_cselect_b32 s63, 99, 5
L_gemm1_kernel_lloop:
  s_mov_b32 m0, s20
  s_add_u32 s20, s20, 16384
  buffer_load_dwordx4 v16, s[28:31], s18 offen lds
  buffer_load_dwordx4 v17, s[28:31], s18 offen offset:1024 lds
  buffer_load_dwordx4 v18, s[28:31], s18 offen offset:2048 lds
  buffer_load_dwordx4 v19, s[28:31], s18 offen offset:3072 lds
  s_and_b32 s20, s20, 65535
  s_add_u32 s18, s18, 128
  s_mov_b32 m0, s21
  s_add_u32 s3, s21, 4096
  buffer_load_dwordx4 v20, s[32:35], s19 offen lds
  buffer_load_dwordx4 v21, s[32:35], s19 offen offset:1024 lds
  buffer_load_dwordx4 v22, s[32:35], s19 offen offset:2048 lds
  buffer_load_dwordx4 v23, s[32:35], s19 offen offset:3072 lds
  s_mov_b32 m0, s3
  s_add_u32 s21, s21, 20480
  buffer_load_dwordx4 v24, s[32:35], s19 offen lds
  s_sub_u32 s3, s21, 81920
  s_cmp_ge_u32 s21, 147456
  s_cselect_b32 s21, s3, s21
  s_add_u32 s19, s19, s23
  s_add_u32 s61, s61, 1
  s_cmp_eq_u32 s61, 10
  s_cselect_b32 s3, 1280, 0
  s_cselect_b32 s26, s60, 0
  s_sub_u32 s18, s18, s3
  s_sub_u32 s19, s19, s26
  s_add_u32 s22, s22, 1
  s_cmp_eq_u32 s22, s62
  s_cbranch_scc1 L_gemm1_kernel_lri
L_gemm1_kernel_lrir:
  s_waitcnt vmcnt(18)
  s_barrier
  s_cmp_eq_u32 s22, s63
  s_cbranch_scc1 L_gemm1_kernel_lrp
L_gemm1_kernel_lrpr:
  s_cmp_lt_u32 s22, 7
  s_cbranch_scc1 L_gemm1_kernel_lloop
  s_cmp_eq_u32 s15, 0
  s_cbranch_scc1 L_gemm1_kernel_lgather
  s_waitcnt vmcnt(9)
  s_barrier
  s_waitcnt vmcnt(0)
  s_barrier
  s_branch L_gemm1_kernel_fin
L_gemm1_kernel_lri:
  s_mul_i32 s36, s2, 3
  s_add_u32 s36, s36, s15
  s_sub_u32 s36, s36, 1
  s_mul_i32 s3, s36, 52429
  s_lshr_b32 s38, s3, 18
  s_mul_i32 s3, s38, 5
  s_sub_u32 s39, s36, s3
  v_lshrrev_b32 v2, 4, v1
  v_mul_u32_u24 v2, 1280, v2
  v_and_b32 v3, 15, v1
  v_lshl_add_u32 v5, v3, 4, v2
  s_mul_i32 s37, s39, 606208
  s_lshl_b32 s3, s38, 10
  s_add_u32 s37, s37, s3
  s_add_u32 s37, s37, 12582912
  s_cmp_lt_u32 s36, 740
  s_cselect_b32 s37, s37, 1073741824
  s_lshl_b32 s36, s15, 12
  s_add_u32 s36, s36, 147456
  s_mov_b32 m0, s36
  s_mov_b32 s42, 0xc8000
  s_mov_b32 s43, 0x00020000
  s_cmp_lt_u32 s38, 108
  s_cselect_b32 s42, 0x21c000, s42
  s_cselect_b32 s3, 0, 108
  s_cselect_b32 s40, s54, s52
  s_cselect_b32 s41, s55, s53
  s_sub_u32 s3, s38, s3
  s_mul_i32 s3, s3, 20480
  s_lshl_b32 s39, s39, 8
  s_add_u32 s3, s3, s39
  buffer_load_dwordx4 v5, s[40:43], s3 offen offset:0 lds
  s_add_u32 s3, s3, 4096
  buffer_load_dwordx4 v5, s[40:43], s3 offen offset:1024 lds
  s_add_u32 s3, s3, 4096
  buffer_load_dwordx4 v5, s[40:43], s3 offen offset:2048 lds
  s_add_u32 s3, s3, 4096
  buffer_load_dwordx4 v5, s[40:43], s3 offen offset:3072 lds
  s_add_u32 s3, s3, 4096
  v_lshrrev_b32 v2, 5, v1
  v_bfe_u32 v3, v1, 2, 2
  v_lshl_add_u32 v2, v2, 2, v3
  v_mul_u32_u24 v2, 256, v2
  v_bfe_u32 v3, v1, 4, 1
  v_lshl_add_u32 v2, v3, 5, v2
  v_and_b32 v3, 3, v1
  v_lshl_add_u32 v5, v3, 3, v2
  v_add_u32 v5, s36, v5
  s_branch L_gemm1_kernel_lrir
L_gemm1_kernel_lrp:
  ds_read_b64_tr_b16 v[32:33], v5 offset:0
  ds_read_b64_tr_b16 v[34:35], v5 offset:2048
  ds_read_b64_tr_b16 v[36:37], v5 offset:64
  ds_read_b64_tr_b16 v[38:39], v5 offset:2112
  ds_read_b64_tr_b16 v[40:41], v5 offset:128
  ds_read_b64_tr_b16 v[42:43], v5 offset:2176
  ds_read_b64_tr_b16 v[44:45], v5 offset:192
  ds_read_b64_tr_b16 v[46:47], v5 offset:2240
  v_lshlrev_b32 v2, 4, v1
  s_waitcnt lgkmcnt(0)
  buffer_store_dwordx4 v[32:35], v2, s[8:11], s37 offen sc0 sc1
  s_add_u32 s37, s37, 151552
  buffer_store_dwordx4 v[36:39], v2, s[8:11], s37 offen sc0 sc1
  s_add_u32 s37, s37, 151552
  buffer_store_dwordx4 v[40:43], v2, s[8:11], s37 offen sc0 sc1
  s_add_u32 s37, s37, 151552
  buffer_store_dwordx4 v[44:47], v2, s[8:11], s37 offen sc0 sc1
  s_add_u32 s37, s37, 151552
  s_branch L_gemm1_kernel_lrpr
L_gemm1_kernel_lgather:
  s_lshl_b32 s26, s13, 4
  v_mov_b32 v2, 0
  s_mov_b32 s27, 0
  buffer_load_dwordx4 v[28:31], v2, s[64:67], s26 offen sc0 sc1
  s_waitcnt vmcnt(10)
  s_barrier
L_gemm1_kernel_lpoll:
  s_waitcnt vmcnt(0)
  v_and_b32 v28, v28, v29
  v_and_b32 v30, v30, v31
  v_and_b32 v28, v28, v30
  s_add_u32 s27, s27, 1
  v_readfirstlane_b32 s3, v28
  s_cmp_gt_u32 s27, 0x40000
  s_cselect_b32 s3, 0x01010101, s3
  s_cmp_eq_u32 s3, 0x01010101
  s_cbranch_scc1 L_gemm1_kernel_lgot
  s_sleep 4
  buffer_load_dwordx4 v[28:31], v2, s[64:67], s26 offen sc0 sc1
  s_branch L_gemm1_kernel_lpoll
L_gemm1_kernel_lgot:
  v_lshlrev_b32 v2, 3, v1
  s_lshl_b32 s3, s13, 9
  s_add_u32 s3, s3, 15618048
  buffer_load_dwordx2 v[28:29], v2, s[8:11], s3 offen sc0 sc1
  v_add_u32 v2, 155648, v2
  s_barrier
  s_waitcnt vmcnt(0)
  ds_write_b64 v2, v[28:29]
  s_waitcnt lgkmcnt(0)
  s_barrier
  s_branch L_gemm1_kernel_fin
L_gemm1_kernel_lkv:
  s_mov_b32 m0, s20
  s_add_u32 s20, s20, 16384
  buffer_load_dwordx4 v16, s[28:31], s18 offen lds
  buffer_load_dwordx4 v17, s[28:31], s18 offen offset:1024 lds
  buffer_load_dwordx4 v18, s[28:31], s18 offen offset:2048 lds
  buffer_load_dwordx4 v19, s[28:31], s18 offen offset:3072 lds
  s_and_b32 s20, s20, 65535
  s_add_u32 s18, s18, 128
  v_lshlrev_b32 v20, 4, v1
  s_and_b32 s3, s15, 1
  s_mul_i32 s19, s3, 13312
  s_mul_i32 s26, s15, 13312
  s_add_u32 s26, s26, 65536
  s_mov_b32 m0, s26
  s_add_u32 s26, s26, 4096
  buffer_load_dwordx4 v20, s[32:35], s19 offen offset:0 lds
  buffer_load_dwordx4 v20, s[32:35], s19 offen offset:1024 lds
  buffer_load_dwordx4 v20, s[32:35], s19 offen offset:2048 lds
  buffer_load_dwordx4 v20, s[32:35], s19 offen offset:3072 lds
  s_add_u32 s19, s19, 4096
  s_mov_b32 m0, s26
  s_add_u32 s26, s26, 4096
  buffer_load_dwordx4 v20, s[32:35], s19 offen offset:0 lds
  buffer_load_dwordx4 v20, s[32:35], s19 offen offset:1024 lds
  buffer_load_dwordx4 v20, s[32:35], s19 offen offset:2048 lds
  buffer_load_dwordx4 v20, s[32:35], s19 offen offset:3072 lds
  s_add_u32 s19, s19, 4096
  s_mov_b32 m0, s26
  s_add_u32 s26, s26, 4096
  buffer_load_dwordx4 v20, s[32:35], s19 offen offset:0 lds
  buffer_load_dwordx4 v20, s[32:35], s19 offen offset:1024 lds
  buffer_load_dwordx4 v20, s[32:35], s19 offen offset:2048 lds
  buffer_load_dwordx4 v20, s[32:35], s19 offen offset:3072 lds
  s_add_u32 s19, s19, 4096
  s_mov_b32 m0, s26
  s_add_u32 s26, s26, 4096
  buffer_load_dwordx4 v20, s[32:35], s19 offen offset:0 lds
  s_mov_b32 m0, s20
  s_add_u32 s20, s20, 16384
  buffer_load_dwordx4 v16, s[28:31], s18 offen lds
  buffer_load_dwordx4 v17, s[28:31], s18 offen offset:1024 lds
  buffer_load_dwordx4 v18, s[28:31], s18 offen offset:2048 lds
  buffer_load_dwordx4 v19, s[28:31], s18 offen offset:3072 lds
  s_and_b32 s20, s20, 65535
  s_add_u32 s18, s18, 128
  s_mov_b32 m0, s20
  s_add_u32 s20, s20, 16384
  buffer_load_dwordx4 v16, s[28:31], s18 offen lds
  buffer_load_dwordx4 v17, s[28:31], s18 offen offset:1024 lds
  buffer_load_dwordx4 v18, s[28:31], s18 offen offset:2048 lds
  buffer_load_dwordx4 v19, s[28:31], s18 offen offset:3072 lds
  s_and_b32 s20, s20, 65535
  s_add_u32 s18, s18, 128
  s_waitcnt vmcnt(8)
  s_barrier
  s_cmp_eq_u32 s15, 0
  s_cselect_b32 s62, 99, 3
  s_cselect_b32 s63, 99, 5
L_gemm1_kernel_mloop:
  s_mov_b32 m0, s20
  s_add_u32 s20, s20, 16384
  buffer_load_dwordx4 v16, s[28:31], s18 offen lds
  buffer_load_dwordx4 v17, s[28:31], s18 offen offset:1024 lds
  buffer_load_dwordx4 v18, s[28:31], s18 offen offset:2048 lds
  buffer_load_dwordx4 v19, s[28:31], s18 offen offset:3072 lds
  s_and_b32 s20, s20, 65535
  s_add_u32 s18, s18, 128
  s_add_u32 s22, s22, 1
  s_cmp_eq_u32 s22, s62
  s_cbranch_scc1 L_gemm1_kernel_mri
L_gemm1_kernel_mrir:
  s_waitcnt vmcnt(8)
  s_barrier
  s_cmp_eq_u32 s22, s63
  s_cbranch_scc1 L_gemm1_kernel_mrp
L_gemm1_kernel_mrpr:
  s_cmp_lt_u32 s22, 7
  s_cbranch_scc1 L_gemm1_kernel_mloop
  s_cmp_eq_u32 s15, 0
  s_cbranch_scc1 L_gemm1_kernel_mgather
  s_waitcnt vmcnt(4)
  s_barrier
  s_waitcnt vmcnt(0)
  s_barrier
  s_branch L_gemm1_kernel_fin
L_gemm1_kernel_mri:
  s_mul_i32 s36, s2, 3
  s_add_u32 s36, s36, s15
  s_sub_u32 s36, s36, 1
  s_mul_i32 s3, s36, 52429
  s_lshr_b32 s38, s3, 18
  s_mul_i32 s3, s38, 5
  s_sub_u32 s39, s36, s3
  v_lshrrev_b32 v2, 4, v1
  v_mul_u32_u24 v2, 1280, v2
  v_and_b32 v3, 15, v1
  v_lshl_add_u32 v5, v3, 4, v2
  s_mul_i32 s37, s39, 606208
  s_lshl_b32 s3, s38, 10
  s_add_u32 s37, s37, s3
  s_add_u32 s37, s37, 12582912
  s_cmp_lt_u32 s36, 740
  s_cselect_b32 s37, s37, 1073741824
  s_lshl_b32 s36, s15, 12
  s_add_u32 s36, s36, 147456
  s_mov_b32 m0, s36
  s_mov_b32 s42, 0xc8000
  s_mov_b32 s43, 0x00020000
  s_cmp_lt_u32 s38, 108
  s_cselect_b32 s42, 0x21c000, s42
  s_cselect_b32 s3, 0, 108
  s_cselect_b32 s40, s54, s52
  s_cselect_b32 s41, s55, s53
  s_sub_u32 s3, s38, s3
  s_mul_i32 s3, s3, 20480
  s_lshl_b32 s39, s39, 8
  s_add_u32 s3, s3, s39
  buffer_load_dwordx4 v5, s[40:43], s3 offen offset:0 lds
  s_add_u32 s3, s3, 4096
  buffer_load_dwordx4 v5, s[40:43], s3 offen offset:1024 lds
  s_add_u32 s3, s3, 4096
  buffer_load_dwordx4 v5, s[40:43], s3 offen offset:2048 lds
  s_add_u32 s3, s3, 4096
  buffer_load_dwordx4 v5, s[40:43], s3 offen offset:3072 lds
  s_add_u32 s3, s3, 4096
  v_lshrrev_b32 v2, 5, v1
  v_bfe_u32 v3, v1, 2, 2
  v_lshl_add_u32 v2, v2, 2, v3
  v_mul_u32_u24 v2, 256, v2
  v_bfe_u32 v3, v1, 4, 1
  v_lshl_add_u32 v2, v3, 5, v2
  v_and_b32 v3, 3, v1
  v_lshl_add_u32 v5, v3, 3, v2
  v_add_u32 v5, s36, v5
  s_branch L_gemm1_kernel_mrir
L_gemm1_kernel_mrp:
  ds_read_b64_tr_b16 v[32:33], v5 offset:0
  ds_read_b64_tr_b16 v[34:35], v5 offset:2048
  ds_read_b64_tr_b16 v[36:37], v5 offset:64
  ds_read_b64_tr_b16 v[38:39], v5 offset:2112
  ds_read_b64_tr_b16 v[40:41], v5 offset:128
  ds_read_b64_tr_b16 v[42:43], v5 offset:2176
  ds_read_b64_tr_b16 v[44:45], v5 offset:192
  ds_read_b64_tr_b16 v[46:47], v5 offset:2240
  v_lshlrev_b32 v2, 4, v1
  s_waitcnt lgkmcnt(0)
  buffer_store_dwordx4 v[32:35], v2, s[8:11], s37 offen sc0 sc1
  s_add_u32 s37, s37, 151552
  buffer_store_dwordx4 v[36:39], v2, s[8:11], s37 offen sc0 sc1
  s_add_u32 s37, s37, 151552
  buffer_store_dwordx4 v[40:43], v2, s[8:11], s37 offen sc0 sc1
  s_add_u32 s37, s37, 151552
  buffer_store_dwordx4 v[44:47], v2, s[8:11], s37 offen sc0 sc1
  s_add_u32 s37, s37, 151552
  s_branch L_gemm1_kernel_mrpr
L_gemm1_kernel_mgather:
  s_lshl_b32 s26, s13, 4
  v_mov_b32 v2, 0
  s_mov_b32 s27, 0
  buffer_load_dwordx4 v[28:31], v2, s[64:67], s26 offen sc0 sc1
  s_waitcnt vmcnt(5)
  s_barrier
L_gemm1_kernel_mpoll:
  s_waitcnt vmcnt(0)
  v_and_b32 v28, v28, v29
  v_and_b32 v30, v30, v31
  v_and_b32 v28, v28, v30
  s_add_u32 s27, s27, 1
  v_readfirstlane_b32 s3, v28
  s_cmp_gt_u32 s27, 0x40000
  s_cselect_b32 s3, 0x01010101, s3
  s_cmp_eq_u32 s3, 0x01010101
  s_cbranch_scc1 L_gemm1_kernel_mgot
  s_sleep 4
  buffer_load_dwordx4 v[28:31], v2, s[64:67], s26 offen sc0 sc1
  s_branch L_gemm1_kernel_mpoll
L_gemm1_kernel_mgot:
  v_lshlrev_b32 v2, 3, v1
  s_lshl_b32 s3, s13, 9
  s_add_u32 s3, s3, 15618048
  buffer_load_dwordx2 v[28:29], v2, s[8:11], s3 offen sc0 sc1
  v_add_u32 v2, 155648, v2
  s_barrier
  s_waitcnt vmcnt(0)
  ds_write_b64 v2, v[28:29]
  s_waitcnt lgkmcnt(0)
  s_barrier
  s_branch L_gemm1_kernel_fin
L_gemm1_kernel_compute:
  v_mov_b32 v149, 0x3f803f80
  s_mov_b32 s20, 0
  s_mov_b32 s21, 0
  s_cmp_eq_u32 s12, 0
  s_cbranch_scc1 L_gemm1_kernel_w0
  s_waitcnt lgkmcnt(0)
  s_mul_i32 s26, s2, 3
  s_add_u32 s26, s26, s12
  s_sub_u32 s26, s26, 1
  v_min_u32 v2, 22, v1
  v_lshlrev_b32 v2, 7, v2
  v_min_u32 v3, 8, v1
  v_lshlrev_b32 v3, 7, v3
  s_mul_i32 s3, s26, 2944
  s_mul_i32 s60, s26, 1152
  s_mov_b32 s36, s56
  s_mov_b32 s37, s57
  s_mov_b32 s38, 0x21c000
  s_mov_b32 s39, 0x00020000
  s_mov_b32 s40, s46
  s_mov_b32 s41, s47
  s_mov_b32 s42, 0xc8000
  s_mov_b32 s43, 0x00020000
  buffer_load_dword v152, v2, s[36:39], s3 offen
  buffer_load_dword v153, v3, s[40:43], s60 offen
  s_mov_b32 s28, s44
  s_mov_b32 s29, s45
  s_mov_b32 s30, 0x280000
  s_mov_b32 s31, 0x00020000
  s_mov_b32 s8, s6
  s_mov_b32 s9, s7
  s_mov_b32 s10, 0x1000000
  s_mov_b32 s11, 0x00020000
  s_mov_b32 s64, s4
  s_mov_b32 s65, s5
  s_mov_b32 s66, 0x100
  s_mov_b32 s67, 0x00020000
  s_lshl_b32 s3, s13, 2
  s_add_u32 s3, s3, s12
  s_mul_i32 s27, s3, 40960
  s_mul_i32 s3, s3, 151552
  s_add_u32 s3, s3, 2883584
  s_cmp_lt_u32 s14, 4
  s_cselect_b32 s3, s27, s3
  v_mov_b32 v2, 0
  buffer_load_dword v154, v2, s[8:11], s3 offen
  v_and_b32 v2, 31, v1
  s_lshl_b32 s3, s12, 5
  v_add_u32 v2, s3, v2
  v_bfe_u32 v3, v2, 1, 3
  v_lshrrev_b32 v4, 5, v1
  v_xor_b32 v3, v3, v4
  v_lshlrev_b32 v2, 7, v2
  s_add_u32 s3, s12, 0
  s_and_b32 s3, s3, 3
  s_lshl_b32 s3, s3, 1
  v_xor_b32 v4, s3, v3
  v_lshl_add_u32 v8, v4, 4, v2
  v_mov_b32 v12, v8
  s_add_u32 s3, s12, 1
  s_and_b32 s3, s3, 3
  s_lshl_b32 s3, s3, 1
  v_xor_b32 v4, s3, v3
  v_lshl_add_u32 v9, v4, 4, v2
  v_mov_b32 v13, v9
  s_add_u32 s3, s12, 2
  s_and_b32 s3, s3, 3
  s_lshl_b32 s3, s3, 1
  v_xor_b32 v4, s3, v3
  v_lshl_add_u32 v10, v4, 4, v2
  v_mov_b32 v14, v10
  s_add_u32 s3, s12, 3
  s_and_b32 s3, s3, 3
  s_lshl_b32 s3, s3, 1
  v_xor_b32 v4, s3, v3
  v_lshl_add_u32 v11, v4, 4, v2
  v_mov_b32 v15, v11
  v_mov_b32 v16, 0
  v_mov_b32 v17, 0
  v_mov_b32 v18, 0
  v_mov_b32 v19, 0
  v_mov_b32 v20, 0
  v_mov_b32 v21, 0
  v_mov_b32 v22, 0
  v_mov_b32 v23, 0
  v_mov_b32 v24, 0
  v_mov_b32 v25, 0
  v_mov_b32 v26, 0
  v_mov_b32 v27, 0
  v_mov_b32 v28, 0
  v_mov_b32 v29, 0
  v_mov_b32 v30, 0
  v_mov_b32 v31, 0
  v_mov_b32 v32, 0
  v_mov_b32 v33, 0
  v_mov_b32 v34, 0
  v_mov_b32 v35, 0
  v_mov_b32 v36, 0
  v_mov_b32 v37, 0
  v_mov_b32 v38, 0
  v_mov_b32 v39, 0
  v_mov_b32 v40, 0
  v_mov_b32 v41, 0
  v_mov_b32 v42, 0
  v_mov_b32 v43, 0
  v_mov_b32 v44, 0
  v_mov_b32 v45, 0
  v_mov_b32 v46, 0
  v_mov_b32 v47, 0
  v_mov_b32 v48, 0
  v_mov_b32 v49, 0
  v_mov_b32 v50, 0
  v_mov_b32 v51, 0
  v_mov_b32 v52, 0
  v_mov_b32 v53, 0
  v_mov_b32 v54, 0
  v_mov_b32 v55, 0
  v_mov_b32 v56, 0
  v_mov_b32 v57, 0
  v_mov_b32 v58, 0
  v_mov_b32 v59, 0
  v_mov_b32 v60, 0
  v_mov_b32 v61, 0
  v_mov_b32 v62, 0
  v_mov_b32 v63, 0
  v_mov_b32 v64, 0
  v_mov_b32 v65, 0
  v_mov_b32 v66, 0
  v_mov_b32 v67, 0
  v_mov_b32 v68, 0
  v_mov_b32 v69, 0
  v_mov_b32 v70, 0
  v_mov_b32 v71, 0
  v_mov_b32 v72, 0
  v_mov_b32 v73, 0
  v_mov_b32 v74, 0
  v_mov_b32 v75, 0
  v_mov_b32 v76, 0
  v_mov_b32 v77, 0
  v_mov_b32 v78, 0
  v_mov_b32 v79, 0
  v_mov_b32 v80, 0
  v_mov_b32 v81, 0
  v_mov_b32 v82, 0
  v_mov_b32 v83, 0
  v_mov_b32 v84, 0
  v_mov_b32 v85, 0
  v_mov_b32 v86, 0
  v_mov_b32 v87, 0
  v_mov_b32 v88, 0
  v_mov_b32 v89, 0
  v_mov_b32 v90, 0
  v_mov_b32 v91, 0
  v_mov_b32 v92, 0
  v_mov_b32 v93, 0
  v_mov_b32 v94, 0
  v_mov_b32 v95, 0
  s_branch L_gemm1_kernel_nb
L_gemm1_kernel_w0:
  v_lshrrev_b32 v2, 3, v1
  v_mul_u32_u24 v2, 1280, v2
  v_and_b32 v3, 7, v1
  v_lshl_add_u32 v5, v3, 4, v2
  s_mul_i32 s3, s14, 10240
  s_add_u32 s3, s3, s18
  v_lshlrev_b32 v4, 1, v1
  s_mov_b32 s39, 0x00020000
  s_sub_u32 s60, s14, 4
  s_cmp_lt_u32 s60, 11
  s_cselect_b32 s38, 3456, 0
  s_waitcnt lgkmcnt(0)
  s_mov_b32 s28, s44
  s_mov_b32 s29, s45
  s_mov_b32 s30, 0x280000
  s_mov_b32 s31, 0x00020000
  s_mov_b32 s8, s6
  s_mov_b32 s9, s7
  s_mov_b32 s10, 0x1000000
  s_mov_b32 s11, 0x00020000
  s_mov_b32 s64, s4
  s_mov_b32 s65, s5
  s_mov_b32 s66, 0x100
  s_mov_b32 s67, 0x00020000
  buffer_load_dwordx4 v[96:99], v5, s[28:31], s3 offen offset:0
  buffer_load_dwordx4 v[100:103], v5, s[28:31], s3 offen offset:128
  buffer_load_dwordx4 v[104:107], v5, s[28:31], s3 offen offset:256
  buffer_load_dwordx4 v[108:111], v5, s[28:31], s3 offen offset:384
  buffer_load_dwordx4 v[112:115], v5, s[28:31], s3 offen offset:512
  buffer_load_dwordx4 v[116:119], v5, s[28:31], s3 offen offset:640
  buffer_load_dwordx4 v[120:123], v5, s[28:31], s3 offen offset:768
  buffer_load_dwordx4 v[124:127], v5, s[28:31], s3 offen offset:896
  buffer_load_dwordx4 v[128:131], v5, s[28:31], s3 offen offset:1024
  buffer_load_dwordx4 v[132:135], v5, s[28:31], s3 offen offset:1152
  s_mov_b32 s36, s58
  s_mov_b32 s37, s59
  s_cmp_lt_u32 s14, 4
  s_cselect_b32 s32, s46, s56
  s_cselect_b32 s33, s47, s57
  buffer_load_ushort v136, v4, s[36:39], s17 offen
  buffer_load_ushort v137, v4, s[36:39], s17 offen offset:128
  buffer_load_ushort v138, v4, s[36:39], s17 offen offset:256
  v_and_b32 v2, 31, v1
  s_lshl_b32 s3, s12, 5
  v_add_u32 v2, s3, v2
  v_bfe_u32 v3, v2, 1, 3
  v_lshrrev_b32 v4, 5, v1
  v_xor_b32 v3, v3, v4
  v_lshlrev_b32 v2, 7, v2
  s_add_u32 s3, s12, 0
  s_and_b32 s3, s3, 3
  s_lshl_b32 s3, s3, 1
  v_xor_b32 v4, s3, v3
  v_lshl_add_u32 v8, v4, 4, v2
  v_mov_b32 v12, v8
  s_add_u32 s3, s12, 1
  s_and_b32 s3, s3, 3
  s_lshl_b32 s3, s3, 1
  v_xor_b32 v4, s3, v3
  v_lshl_add_u32 v9, v4, 4, v2
  v_mov_b32 v13, v9
  s_add_u32 s3, s12, 2
  s_and_b32 s3, s3, 3
  s_lshl_b32 s3, s3, 1
  v_xor_b32 v4, s3, v3
  v_lshl_add_u32 v10, v4, 4, v2
  v_mov_b32 v14, v10
  s_add_u32 s3, s12, 3
  s_and_b32 s3, s3, 3
  s_lshl_b32 s3, s3, 1
  v_xor_b32 v4, s3, v3
  v_lshl_add_u32 v11, v4, 4, v2
  v_mov_b32 v15, v11
  v_mov_b32 v16, 0
  v_mov_b32 v17, 0
  v_mov_b32 v18, 0
  v_mov_b32 v19, 0
  v_mov_b32 v20, 0
  v_mov_b32 v21, 0
  v_mov_b32 v22, 0
  v_mov_b32 v23, 0
  v_mov_b32 v24, 0
  v_mov_b32 v25, 0
  v_mov_b32 v26, 0
  v_mov_b32 v27, 0
  v_mov_b32 v28, 0
  v_mov_b32 v29, 0
  v_mov_b32 v30, 0
  v_mov_b32 v31, 0
  v_mov_b32 v32, 0
  v_mov_b32 v33, 0
  v_mov_b32 v34, 0
  v_mov_b32 v35, 0
  v_mov_b32 v36, 0
  v_mov_b32 v37, 0
  v_mov_b32 v38, 0
  v_mov_b32 v39, 0
  v_mov_b32 v40, 0
  v_mov_b32 v41, 0
  v_mov_b32 v42, 0
  v_mov_b32 v43, 0
  v_mov_b32 v44, 0
  v_mov_b32 v45, 0
  v_mov_b32 v46, 0
  v_mov_b32 v47, 0
  v_mov_b32 v48, 0
  v_mov_b32 v49, 0
  v_mov_b32 v50, 0
  v_mov_b32 v51, 0
  v_mov_b32 v52, 0
  v_mov_b32 v53, 0
  v_mov_b32 v54, 0
  v_mov_b32 v55, 0
  v_mov_b32 v56, 0
  v_mov_b32 v57, 0
  v_mov_b32 v58, 0
  v_mov_b32 v59, 0
  v_mov_b32 v60, 0
  v_mov_b32 v61, 0
  v_mov_b32 v62, 0
  v_mov_b32 v63, 0
  v_mov_b32 v64, 0
  v_mov_b32 v65, 0
  v_mov_b32 v66, 0
  v_mov_b32 v67, 0
  v_mov_b32 v68, 0
  v_mov_b32 v69, 0
  v_mov_b32 v70, 0
  v_mov_b32 v71, 0
  v_mov_b32 v72, 0
  v_mov_b32 v73, 0
  v_mov_b32 v74, 0
  v_mov_b32 v75, 0
  v_mov_b32 v76, 0
  v_mov_b32 v77, 0
  v_mov_b32 v78, 0
  v_mov_b32 v79, 0
  v_mov_b32 v80, 0
  v_mov_b32 v81, 0
  v_mov_b32 v82, 0
  v_mov_b32 v83, 0
  v_mov_b32 v84, 0
  v_mov_b32 v85, 0
  v_mov_b32 v86, 0
  v_mov_b32 v87, 0
  v_mov_b32 v88, 0
  v_mov_b32 v89, 0
  v_mov_b32 v90, 0
  v_mov_b32 v91, 0
  v_mov_b32 v92, 0
  v_mov_b32 v93, 0
  v_mov_b32 v94, 0
  v_mov_b32 v95, 0
  s_lshl_b32 s3, s2, 7
  s_add_u32 s3, s3, 15613952
  s_cmp_lt_u32 s2, 32
  s_cselect_b32 s3, s3, 1073741824
  v_lshlrev_b32 v3, 1, v1
  v_and_b32 v3, 0x7c, v3
  buffer_store_dword v16, v3, s[8:11], s3 offen
  v_mov_b32 v144, 0
  v_mov_b32 v145, 0
  v_lshlrev_b32 v2, 4, v1
  v_add_u32 v2, 147456, v2
  ds_write_b128 v2, v[16:19] offset:0
  ds_write_b128 v2, v[16:19] offset:1024
  ds_write_b128 v2, v[16:19] offset:2048
  s_waitcnt vmcnt(13)
  v_dot2c_f32_bf16 v144, v96, v149
  v_dot2c_f32_bf16 v145, v96, v96
  v_dot2c_f32_bf16 v144, v97, v149
  v_dot2c_f32_bf16 v145, v97, v97
  v_dot2c_f32_bf16 v144, v98, v149
  v_dot2c_f32_bf16 v145, v98, v98
  v_dot2c_f32_bf16 v144, v99, v149
  v_dot2c_f32_bf16 v145, v99, v99
  s_waitcnt vmcnt(12)
  v_dot2c_f32_bf16 v144, v100, v149
  v_dot2c_f32_bf16 v145, v100, v100
  v_dot2c_f32_bf16 v144, v101, v149
  v_dot2c_f32_bf16 v145, v101, v101
  v_dot2c_f32_bf16 v144, v102, v149
  v_dot2c_f32_bf16 v145, v102, v102
  v_dot2c_f32_bf16 v144, v103, v149
  v_dot2c_f32_bf16 v145, v103, v103
  s_waitcnt vmcnt(11)
  v_dot2c_f32_bf16 v144, v104, v149
  v_dot2c_f32_bf16 v145, v104, v104
  v_dot2c_f32_bf16 v144, v105, v149
  v_dot2c_f32_bf16 v145, v105, v105
  v_dot2c_f32_bf16 v144, v106, v149
  v_dot2c_f32_bf16 v145, v106, v106
  v_dot2c_f32_bf16 v144, v107, v149
  v_dot2c_f32_bf16 v145, v107, v107
  s_waitcnt vmcnt(10)
  v_dot2c_f32_bf16 v144, v108, v149
  v_dot2c_f32_bf16 v145, v108, v108
  v_dot2c_f32_bf16 v144, v109, v149
  v_dot2c_f32_bf16 v145, v109, v109
  v_dot2c_f32_bf16 v144, v110, v149
  v_dot2c_f32_bf16 v145, v110, v110
  v_dot2c_f32_bf16 v144, v111, v149
  v_dot2c_f32_bf16 v145, v111, v111
  s_waitcnt vmcnt(9)
  v_dot2c_f32_bf16 v144, v112, v149
  v_dot2c_f32_bf16 v145, v112, v112
  v_dot2c_f32_bf16 v144, v113, v149
  v_dot2c_f32_bf16 v145, v113, v113
  v_dot2c_f32_bf16 v144, v114, v149
  v_dot2c_f32_bf16 v145, v114, v114
  v_dot2c_f32_bf16 v144, v115, v149
  v_dot2c_f32_bf16 v145, v115, v115
  s_waitcnt vmcnt(8)
  v_dot2c_f32_bf16 v144, v116, v149
  v_dot2c_f32_bf16 v145, v116, v116
  v_dot2c_f32_bf16 v144, v117, v149
  v_dot2c_f32_bf16 v145, v117, v117
  v_dot2c_f32_bf16 v144, v118, v149
  v_dot2c_f32_bf16 v145, v118, v118
  v_dot2c_f32_bf16 v144, v119, v149
  v_dot2c_f32_bf16 v145, v119, v119
  s_waitcnt vmcnt(7)
  v_dot2c_f32_bf16 v144, v120, v149
  v_dot2c_f32_bf16 v145, v120, v120
  v_dot2c_f32_bf16 v144, v121, v149
  v_dot2c_f32_bf16 v145, v121, v121
  v_dot2c_f32_bf16 v144, v122, v149
  v_dot2c_f32_bf16 v145, v122, v122
  v_dot2c_f32_bf16 v144, v123, v149
  v_dot2c_f32_bf16 v145, v123, v123
  s_waitcnt vmcnt(6)
  v_dot2c_f32_bf16 v144, v124, v149
  v_dot2c_f32_bf16 v145, v124, v124
  v_dot2c_f32_bf16 v144, v125, v149
  v_dot2c_f32_bf16 v145, v125, v125
  v_dot2c_f32_bf16 v144, v126, v149
  v_dot2c_f32_bf16 v145, v126, v126
  v_dot2c_f32_bf16 v144, v127, v149
  v_dot2c_f32_bf16 v145, v127, v127
  s_waitcnt vmcnt(5)
  v_dot2c_f32_bf16 v144, v128, v149
  v_dot2c_f32_bf16 v145, v128, v128
  v_dot2c_f32_bf16 v144, v129, v149
  v_dot2c_f32_bf16 v145, v129, v129
  v_dot2c_f32_bf16 v144, v130, v149
  v_dot2c_f32_bf16 v145, v130, v130
  v_dot2c_f32_bf16 v144, v131, v149
  v_dot2c_f32_bf16 v145, v131, v131
  s_waitcnt vmcnt(4)
  v_dot2c_f32_bf16 v144, v132, v149
  v_dot2c_f32_bf16 v145, v132, v132
  v_dot2c_f32_bf16 v144, v133, v149
  v_dot2c_f32_bf16 v145, v133, v133
  v_dot2c_f32_bf16 v144, v134, v149
  v_dot2c_f32_bf16 v145, v134, v134
  v_dot2c_f32_bf16 v144, v135, v149
  v_dot2c_f32_bf16 v145, v135, v135
  s_waitcnt vmcnt(1)
  ds_write_b32 v2, v136 offset:0
  ds_write_b32 v2, v137 offset:1024
  ds_write_b32 v2, v138 offset:2048
  v_add_f32_dpp v144, v144, v144 quad_perm:[1,0,3,2] row_mask:0xf bank_mask:0xf
  v_add_f32_dpp v145, v145, v145 quad_perm:[1,0,3,2] row_mask:0xf bank_mask:0xf
  s_nop 0
  v_add_f32_dpp v144, v144, v144 quad_perm:[2,3,0,1] row_mask:0xf bank_mask:0xf
  v_add_f32_dpp v145, v145, v145 quad_perm:[2,3,0,1] row_mask:0xf bank_mask:0xf
  s_nop 0
  v_add_f32_dpp v144, v144, v144 row_half_mirror row_mask:0xf bank_mask:0xf
  v_add_f32_dpp v145, v145, v145 row_half_mirror row_mask:0xf bank_mask:0xf
  s_nop 0
  v_mul_f32 v144, 0x3acccccd, v144
  v_mul_f32 v145, 0x3acccccd, v145
  v_fma_f32 v145, -v144, v144, v145
  v_max_f32 v145, 0, v145
  v_cvt_pk_bf16_f32 v145, v145, v145
  v_and_b32 v145, 0xffff0000, v145
  v_add_f32 v145, 0x3727c5ac, v145
  v_cvt_pk_bf16_f32 v145, v145, v145
  v_and_b32 v145, 0xffff0000, v145
  v_sqrt_f32 v145, v145
  v_lshrrev_b32 v2, 3, v1
  v_lshlrev_b32 v2, 2, v2
  s_lshl_b32 s3, s13, 9
  s_lshl_b32 s60, s14, 5
  s_add_u32 s3, s3, s60
  s_add_u32 s3, s3, 15618048
  v_cvt_pk_bf16_f32 v3, -v144, v145
  s_mov_b32 exec_lo, 0x01010101
  s_mov_b32 exec_hi, 0x01010101
  buffer_store_dword v3, v2, s[8:11], s3 offen sc0 sc1
  s_mov_b64 exec, -1
  s_waitcnt lgkmcnt(0)
L_gemm1_kernel_nb:
  v_mov_b32 v160, 0
  v_mov_b32 v161, 0
  v_mov_b32 v162, 0
  v_mov_b32 v163, 0
  v_mov_b32 v164, 0
  v_mov_b32 v165, 0
  v_mov_b32 v166, 0
  v_mov_b32 v167, 0
  v_mov_b32 v168, 0
  v_mov_b32 v169, 0
  v_mov_b32 v170, 0
  v_mov_b32 v171, 0
  v_mov_b32 v172, 0
  v_mov_b32 v173, 0
  v_mov_b32 v174, 0
  v_mov_b32 v175, 0
  v_mov_b32 v176, 0
  v_mov_b32 v177, 0
  v_mov_b32 v178, 0
  v_mov_b32 v179, 0
  v_lshrrev_b32 v2, 4, v1
  v_xor_b32 v2, v2, v1
  v_and_b32 v2, 1, v2
  v_cmp_eq_u32 vcc, 0, v2
  s_mov_b32 s60, 0xffff0000
  s_mov_b32 s61, 0xffff0000
  v_cndmask_b32 v156, 0, v149, vcc
  v_cndmask_b32 v157, 0, v149, vcc
  v_cndmask_b32 v158, 0, v149, vcc
  v_cndmask_b32 v159, 0, v149, vcc
  s_cmp_eq_u32 s14, 15
  s_cbranch_scc1 L_gemm1_kernel_ckv
  v_lshrrev_b32 v2, 5, v1
  v_bfe_u32 v3, v1, 2, 2
  v_lshl_add_u32 v2, v2, 3, v3
  v_mul_u32_u24 v2, 320, v2
  v_bfe_u32 v3, v1, 4, 1
  v_lshl_add_u32 v2, v3, 5, v2
  v_and_b32 v3, 3, v1
  v_lshl_add_u32 v4, v3, 3, v2
  s_add_u32 s3, s12, 0
  s_and_b32 s3, s3, 3
  s_mul_i32 s3, s3, 5120
  s_add_u32 s3, s3, 65536
  v_add_u32 v180, s3, v4
  v_mov_b32 v184, v180
  s_add_u32 s3, s12, 1
  s_and_b32 s3, s3, 3
  s_mul_i32 s3, s3, 5120
  s_add_u32 s3, s3, 65536
  v_add_u32 v181, s3, v4
  v_mov_b32 v185, v181
  s_add_u32 s3, s12, 2
  s_and_b32 s3, s3, 3
  s_mul_i32 s3, s3, 5120
  s_add_u32 s3, s3, 65536
  v_add_u32 v182, s3, v4
  v_mov_b32 v186, v182
  s_add_u32 s3, s12, 3
  s_and_b32 s3, s3, 3
  s_mul_i32 s3, s3, 5120
  s_add_u32 s3, s3, 65536
  v_add_u32 v183, s3, v4
  v_mov_b32 v187, v183
  s_cmp_eq_u32 s12, 0
  s_cselect_b32 s63, 2, 99
  s_barrier
  ds_read_b128 v[96:99], v12
  ds_read_b64_tr_b16 v[100:101], v184 offset:0
  ds_read_b64_tr_b16 v[102:103], v184 offset:1280
  ds_read_b64_tr_b16 v[104:105], v184 offset:64
  ds_read_b64_tr_b16 v[106:107], v184 offset:1344
  ds_read_b64_tr_b16 v[108:109], v184 offset:128
  ds_read_b64_tr_b16 v[110:111], v184 offset:1408
  ds_read_b64_tr_b16 v[112:113], v184 offset:192
  ds_read_b64_tr_b16 v[114:115], v184 offset:1472
  ds_read_b64_tr_b16 v[116:117], v184 offset:256
  ds_read_b64_tr_b16 v[118:119], v184 offset:1536
  .p2align 6
L_gemm1_kernel_cloop:
  s_waitcnt lgkmcnt(8)
  v_mfma_f32_32x32x16_bf16 v[16:31], v[100:103], v[96:99], v[16:31]
  ds_read_b128 v[120:123], v13
  ds_read_b64_tr_b16 v[124:125], v185 offset:0
  ds_read_b64_tr_b16 v[126:127], v185 offset:1280
  s_waitcnt lgkmcnt(9)
  v_mfma_f32_32x32x16_bf16 v[32:47], v[104:107], v[96:99], v[32:47]
  ds_read_b64_tr_b16 v[128:129], v185 offset:64
  ds_read_b64_tr_b16 v[130:131], v185 offset:1344
  ds_read_b64_tr_b16 v[132:133], v185 offset:128
  s_waitcnt lgkmcnt(10)
  v_mfma_f32_32x32x16_bf16 v[48:63], v[108:111], v[96:99], v[48:63]
  ds_read_b64_tr_b16 v[134:135], v185 offset:1408
  ds_read_b64_tr_b16 v[136:137], v185 offset:192
  ds_read_b64_tr_b16 v[138:139], v185 offset:1472
  s_waitcnt lgkmcnt(11)
  v_mfma_f32_32x32x16_bf16 v[64:79], v[112:115], v[96:99], v[64:79]
  ds_read_b64_tr_b16 v[140:141], v185 offset:256
  ds_read_b64_tr_b16 v[142:143], v185 offset:1536
  s_waitcnt lgkmcnt(11)
  v_mfma_f32_32x32x16_bf16 v[80:95], v[116:119], v[96:99], v[80:95]
  v_add_u32 v14, s20, v10
  v_add_u32 v186, s21, v182
  v_add_u32 v15, s20, v11
  v_add_u32 v187, s21, v183
  v_mfma_f32_16x16x32_bf16 v[160:163], v[156:159], v[100:103], v[160:163]
  v_mfma_f32_16x16x32_bf16 v[164:167], v[156:159], v[104:107], v[164:167]
  v_mfma_f32_16x16x32_bf16 v[168:171], v[156:159], v[108:111], v[168:171]
  v_mfma_f32_16x16x32_bf16 v[172:175], v[156:159], v[112:115], v[172:175]
  v_mfma_f32_16x16x32_bf16 v[176:179], v[156:159], v[116:119], v[176:179]
  s_waitcnt lgkmcnt(8)
  v_mfma_f32_32x32x16_bf16 v[16:31], v[124:127], v[120:123], v[16:31]
  ds_read_b128 v[96:99], v14
  ds_read_b64_tr_b16 v[100:101], v186 offset:0
  ds_read_b64_tr_b16 v[102:103], v186 offset:1280
  s_waitcnt lgkmcnt(9)
  v_mfma_f32_32x32x16_bf16 v[32:47], v[128:131], v[120:123], v[32:47]
  ds_read_b64_tr_b16 v[104:105], v186 offset:64
  ds_read_b64_tr_b16 v[106:107], v186 offset:1344
  ds_read_b64_tr_b16 v[108:109], v186 offset:128
  s_waitcnt lgkmcnt(10)
  v_mfma_f32_32x32x16_bf16 v[48:63], v[132:135], v[120:123], v[48:63]
  ds_read_b64_tr_b16 v[110:111], v186 offset:1408
  ds_read_b64_tr_b16 v[112:113], v186 offset:192
  ds_read_b64_tr_b16 v[114:115], v186 offset:1472
  s_waitcnt lgkmcnt(11)
  v_mfma_f32_32x32x16_bf16 v[64:79], v[136:139], v[120:123], v[64:79]
  ds_read_b64_tr_b16 v[116:117], v186 offset:256
  ds_read_b64_tr_b16 v[118:119], v186 offset:1536
  s_waitcnt lgkmcnt(11)
  v_mfma_f32_32x32x16_bf16 v[80:95], v[140:143], v[120:123], v[80:95]
  s_cmp_eq_u32 s22, s63
  s_cbranch_scc1 L_gemm1_kernel_cpub
L_gemm1_kernel_cpubret:
  s_waitcnt lgkmcnt(8)
  v_mfma_f32_32x32x16_bf16 v[16:31], v[100:103], v[96:99], v[16:31]
  ds_read_b128 v[120:123], v15
  ds_read_b64_tr_b16 v[124:125], v187 offset:0
  ds_read_b64_tr_b16 v[126:127], v187 offset:1280
  s_waitcnt lgkmcnt(9)
  v_mfma_f32_32x32x16_bf16 v[32:47], v[104:107], v[96:99], v[32:47]
  ds_read_b64_tr_b16 v[128:129], v187 offset:64
  ds_read_b64_tr_b16 v[130:131], v187 offset:1344
  ds_read_b64_tr_b16 v[132:133], v187 offset:128
  s_waitcnt lgkmcnt(10)
  v_mfma_f32_32x32x16_bf16 v[48:63], v[108:111], v[96:99], v[48:63]
  ds_read_b64_tr_b16 v[134:135], v187 offset:1408
  ds_read_b64_tr_b16 v[136:137], v187 offset:192
  ds_read_b64_tr_b16 v[138:139], v187 offset:1472
  s_waitcnt lgkmcnt(11)
  v_mfma_f32_32x32x16_bf16 v[64:79], v[112:115], v[96:99], v[64:79]
  ds_read_b64_tr_b16 v[140:141], v187 offset:256
  ds_read_b64_tr_b16 v[142:143], v187 offset:1536
  s_waitcnt lgkmcnt(11)
  v_mfma_f32_32x32x16_bf16 v[80:95], v[116:119], v[96:99], v[80:95]
  s_add_u32 s20, s20, 16384
  s_and_b32 s20, s20, 65535
  s_add_u32 s21, s21, 20480
  s_cmp_eq_u32 s21, 81920
  s_cselect_b32 s21, 0, s21
  s_waitcnt lgkmcnt(8)
  v_mfma_f32_32x32x16_bf16 v[16:31], v[124:127], v[120:123], v[16:31]
  v_add_u32 v12, s20, v8
  v_add_u32 v184, s21, v180
  v_add_u32 v13, s20, v9
  v_add_u32 v185, s21, v181
  s_add_u32 s22, s22, 1
  s_cmp_eq_u32 s22, 10
  s_waitcnt lgkmcnt(6)
  v_mfma_f32_32x32x16_bf16 v[32:47], v[128:131], v[120:123], v[32:47]
  s_waitcnt lgkmcnt(0)
  s_cbranch_scc1 L_gemm1_kernel_cnobar
  s_barrier
L_gemm1_kernel_cnobar:
  ds_read_b128 v[96:99], v12
  ds_read_b64_tr_b16 v[100:101], v184 offset:0
  ds_read_b64_tr_b16 v[102:103], v184 offset:1280
  v_mfma_f32_32x32x16_bf16 v[48:63], v[132:135], v[120:123], v[48:63]
  ds_read_b64_tr_b16 v[104:105], v184 offset:64
  ds_read_b64_tr_b16 v[106:107], v184 offset:1344
  ds_read_b64_tr_b16 v[108:109], v184 offset:128
  v_mfma_f32_32x32x16_bf16 v[64:79], v[136:139], v[120:123], v[64:79]
  ds_read_b64_tr_b16 v[110:111], v184 offset:1408
  ds_read_b64_tr_b16 v[112:113], v184 offset:192
  ds_read_b64_tr_b16 v[114:115], v184 offset:1472
  v_mfma_f32_32x32x16_bf16 v[80:95], v[140:143], v[120:123], v[80:95]
  ds_read_b64_tr_b16 v[116:117], v184 offset:256
  ds_read_b64_tr_b16 v[118:119], v184 offset:1536
  s_cbranch_scc0 L_gemm1_kernel_cloop
  s_branch L_gemm1_kernel_cdone
L_gemm1_kernel_cpub:
  s_lshl_b32 s3, s13, 4
  s_add_u32 s3, s3, s14
  v_mov_b32 v2, 0
  v_mov_b32 v3, 1
  s_mov_b64 exec, 1
  s_waitcnt vmcnt(0)
  buffer_store_byte v3, v2, s[64:67], s3 offen sc0 sc1
  s_mov_b64 exec, -1
  s_branch L_gemm1_kernel_cpubret
L_gemm1_kernel_cdone:
  s_waitcnt lgkmcnt(0)
  v_and_b32 v2, 31, v1
  s_lshl_b32 s3, s12, 2
  s_add_u32 s3, s3, 151552
  v_lshl_add_u32 v5, v2, 4, s3
  v_lshlrev_b32 v3, 4, v2
  v_add_u32 v4, 151552, v3
  v_cndmask_b32 v144, v160, v161, s[60:61]
  v_cndmask_b32 v145, v164, v165, s[60:61]
  v_cndmask_b32 v146, v168, v169, s[60:61]
  v_cndmask_b32 v147, v172, v173, s[60:61]
  v_cndmask_b32 v148, v176, v177, s[60:61]
  v_and_b32 v96, 0xffff0000, v144
  v_and_b32 v97, 0xffff0000, v145
  v_and_b32 v98, 0xffff0000, v146
  v_and_b32 v99, 0xffff0000, v147
  v_and_b32 v100, 0xffff0000, v148
  v_sub_f32 v144, v144, v96
  v_sub_f32 v145, v145, v97
  v_sub_f32 v146, v146, v98
  v_sub_f32 v147, v147, v99
  v_sub_f32 v148, v148, v100
  v_cvt_pk_bf16_f32 v144, v96, v144
  v_cvt_pk_bf16_f32 v145, v97, v145
  v_cvt_pk_bf16_f32 v146, v98, v146
  v_cvt_pk_bf16_f32 v147, v99, v147
  v_cvt_pk_bf16_f32 v148, v100, v148
  ds_write_b32 v5, v144 offset:0
  ds_write_b32 v5, v145 offset:512
  ds_write_b32 v5, v146 offset:1024
  ds_write_b32 v5, v147 offset:1536
  ds_write_b32 v5, v148 offset:2048
  v_add_u32 v3, 147456, v3
  v_cndmask_b32 v3, v4, v3, s[24:25]
  s_lshl_b32 s3, s12, 7
  s_add_u32 s3, s3, 155648
  v_lshl_add_u32 v2, v2, 2, s3
  s_waitcnt lgkmcnt(0)
  s_barrier
  ds_read_b32 v5, v2
  ds_read_b128 v[124:127], v3 offset:0
  ds_read_b128 v[128:131], v3 offset:512
  ds_read_b128 v[132:135], v3 offset:1024
  ds_read_b128 v[136:139], v3 offset:1536
  ds_read_b128 v[140:143], v3 offset:2048
  s_waitcnt lgkmcnt(5)
  v_and_b32 v2, 0xffff, v5
  v_lshl_or_b32 v2, v2, 16, v2
  v_lshrrev_b32 v3, 16, v5
  v_and_b32 v150, 0xffff0000, v5
  v_rcp_f32 v150, v150
  v_cndmask_b32 v120, v2, v3, s[24:25]
  v_cndmask_b32 v121, v2, 0, s[24:25]
  v_cndmask_b32 v122, v2, 0, s[24:25]
  v_cndmask_b32 v123, v2, 0, s[24:25]
  s_waitcnt lgkmcnt(0)
  s_nop 0
  v_mfma_f32_32x32x16_bf16 v[16:31], v[124:127], v[120:123], v[16:31]
  v_mfma_f32_32x32x16_bf16 v[32:47], v[128:131], v[120:123], v[32:47]
  v_mfma_f32_32x32x16_bf16 v[48:63], v[132:135], v[120:123], v[48:63]
  v_mfma_f32_32x32x16_bf16 v[64:79], v[136:139], v[120:123], v[64:79]
  v_mfma_f32_32x32x16_bf16 v[80:95], v[140:143], v[120:123], v[80:95]
  s_lshl_b32 s26, s13, 2
  s_add_u32 s26, s26, s12
  s_nop 9
  s_cmp_ge_u32 s14, 4
  s_cbranch_scc1 L_gemm1_kernel_eph
  v_mul_f32 v150, 0x3ea52b5c, v150
  s_mul_i32 s26, s26, 40960
  s_mul_i32 s3, s14, 10240
  s_add_u32 s26, s26, s3
  v_lshlrev_b32 v2, 3, v1
  v_pk_mul_f32 v[16:17], v[16:17], v[150:151] op_sel_hi:[1,0]
  v_pk_mul_f32 v[18:19], v[18:19], v[150:151] op_sel_hi:[1,0]
  v_pk_mul_f32 v[20:21], v[20:21], v[150:151] op_sel_hi:[1,0]
  v_pk_mul_f32 v[22:23], v[22:23], v[150:151] op_sel_hi:[1,0]
  v_pk_mul_f32 v[24:25], v[24:25], v[150:151] op_sel_hi:[1,0]
  v_pk_mul_f32 v[26:27], v[26:27], v[150:151] op_sel_hi:[1,0]
  v_pk_mul_f32 v[28:29], v[28:29], v[150:151] op_sel_hi:[1,0]
  v_pk_mul_f32 v[30:31], v[30:31], v[150:151] op_sel_hi:[1,0]
  v_cvt_pk_bf16_f32 v16, v16, v17
  v_cvt_pk_bf16_f32 v17, v18, v19
  v_cvt_pk_bf16_f32 v18, v20, v21
  v_cvt_pk_bf16_f32 v19, v22, v23
  v_cvt_pk_bf16_f32 v20, v24, v25
  v_cvt_pk_bf16_f32 v21, v26, v27
  v_cvt_pk_bf16_f32 v22, v28, v29
  v_cvt_pk_bf16_f32 v23, v30, v31
  buffer_store_dwordx2 v[16:17], v2, s[8:11], s26 offen offset:0 sc0 sc1
  buffer_store_dwordx2 v[18:19], v2, s[8:11], s26 offen offset:512 sc0 sc1
  buffer_store_dwordx2 v[20:21], v2, s[8:11], s26 offen offset:1024 sc0 sc1
  buffer_store_dwordx2 v[22:23], v2, s[8:11], s26 offen offset:1536 sc0 sc1
  v_pk_mul_f32 v[32:33], v[32:33], v[150:151] op_sel_hi:[1,0]
  v_pk_mul_f32 v[34:35], v[34:35], v[150:151] op_sel_hi:[1,0]
  v_pk_mul_f32 v[36:37], v[36:37], v[150:151] op_sel_hi:[1,0]
  v_pk_mul_f32 v[38:39], v[38:39], v[150:151] op_sel_hi:[1,0]
  v_pk_mul_f32 v[40:41], v[40:41], v[150:151] op_sel_hi:[1,0]
  v_pk_mul_f32 v[42:43], v[42:43], v[150:151] op_sel_hi:[1,0]
  v_pk_mul_f32 v[44:45], v[44:45], v[150:151] op_sel_hi:[1,0]
  v_pk_mul_f32 v[46:47], v[46:47], v[150:151] op_sel_hi:[1,0]
  v_cvt_pk_bf16_f32 v32, v32, v33
  v_cvt_pk_bf16_f32 v33, v34, v35
  v_cvt_pk_bf16_f32 v34, v36, v37
  v_cvt_pk_bf16_f32 v35, v38, v39
  v_cvt_pk_bf16_f32 v36, v40, v41
  v_cvt_pk_bf16_f32 v37, v42, v43
  v_cvt_pk_bf16_f32 v38, v44, v45
  v_cvt_pk_bf16_f32 v39, v46, v47
  buffer_store_dwordx2 v[32:33], v2, s[8:11], s26 offen offset:2048 sc0 sc1
  buffer_store_dwordx2 v[34:35], v2, s[8:11], s26 offen offset:2560 sc0 sc1
  buffer_store_dwordx2 v[36:37], v2, s[8:11], s26 offen offset:3072 sc0 sc1
  buffer_store_dwordx2 v[38:39], v2, s[8:11], s26 offen offset:3584 sc0 sc1
  s_add_u32 s26, s26, 4096
  v_pk_mul_f32 v[48:49], v[48:49], v[150:151] op_sel_hi:[1,0]
  v_pk_mul_f32 v[50:51], v[50:51], v[150:151] op_sel_hi:[1,0]
  v_pk_mul_f32 v[52:53], v[52:53], v[150:151] op_sel_hi:[1,0]
  v_pk_mul_f32 v[54:55], v[54:55], v[150:151] op_sel_hi:[1,0]
  v_pk_mul_f32 v[56:57], v[56:57], v[150:151] op_sel_hi:[1,0]
  v_pk_mul_f32 v[58:59], v[58:59], v[150:151] op_sel_hi:[1,0]
  v_pk_mul_f32 v[60:61], v[60:61], v[150:151] op_sel_hi:[1,0]
  v_pk_mul_f32 v[62:63], v[62:63], v[150:151] op_sel_hi:[1,0]
  v_cvt_pk_bf16_f32 v48, v48, v49
  v_cvt_pk_bf16_f32 v49, v50, v51
  v_cvt_pk_bf16_f32 v50, v52, v53
  v_cvt_pk_bf16_f32 v51, v54, v55
  v_cvt_pk_bf16_f32 v52, v56, v57
  v_cvt_pk_bf16_f32 v53, v58, v59
  v_cvt_pk_bf16_f32 v54, v60, v61
  v_cvt_pk_bf16_f32 v55, v62, v63
  buffer_store_dwordx2 v[48:49], v2, s[8:11], s26 offen offset:0 sc0 sc1
  buffer_store_dwordx2 v[50:51], v2, s[8:11], s26 offen offset:512 sc0 sc1
  buffer_store_dwordx2 v[52:53], v2, s[8:11], s26 offen offset:1024 sc0 sc1
  buffer_store_dwordx2 v[54:55], v2, s[8:11], s26 offen offset:1536 sc0 sc1
  v_pk_mul_f32 v[64:65], v[64:65], v[150:151] op_sel_hi:[1,0]
  v_pk_mul_f32 v[66:67], v[66:67], v[150:151] op_sel_hi:[1,0]
  v_pk_mul_f32 v[68:69], v[68:69], v[150:151] op_sel_hi:[1,0]
  v_pk_mul_f32 v[70:71], v[70:71], v[150:151] op_sel_hi:[1,0]
  v_pk_mul_f32 v[72:73], v[72:73], v[150:151] op_sel_hi:[1,0]
  v_pk_mul_f32 v[74:75], v[74:75], v[150:151] op_sel_hi:[1,0]
  v_pk_mul_f32 v[76:77], v[76:77], v[150:151] op_sel_hi:[1,0]
  v_pk_mul_f32 v[78:79], v[78:79], v[150:151] op_sel_hi:[1,0]
  v_cvt_pk_bf16_f32 v64, v64, v65
  v_cvt_pk_bf16_f32 v65, v66, v67
  v_cvt_pk_bf16_f32 v66, v68, v69
  v_cvt_pk_bf16_f32 v67, v70, v71
  v_cvt_pk_bf16_f32 v68, v72, v73
  v_cvt_pk_bf16_f32 v69, v74, v75
  v_cvt_pk_bf16_f32 v70, v76, v77
  v_cvt_pk_bf16_f32 v71, v78, v79
  buffer_store_dwordx2 v[64:65], v2, s[8:11], s26 offen offset:2048 sc0 sc1
  buffer_store_dwordx2 v[66:67], v2, s[8:11], s26 offen offset:2560 sc0 sc1
  buffer_store_dwordx2 v[68:69], v2, s[8:11], s26 offen offset:3072 sc0 sc1
  buffer_store_dwordx2 v[70:71], v2, s[8:11], s26 offen offset:3584 sc0 sc1
  s_add_u32 s26, s26, 4096
  v_pk_mul_f32 v[80:81], v[80:81], v[150:151] op_sel_hi:[1,0]
  v_pk_mul_f32 v[82:83], v[82:83], v[150:151] op_sel_hi:[1,0]
  v_pk_mul_f32 v[84:85], v[84:85], v[150:151] op_sel_hi:[1,0]
  v_pk_mul_f32 v[86:87], v[86:87], v[150:151] op_sel_hi:[1,0]
  v_pk_mul_f32 v[88:89], v[88:89], v[150:151] op_sel_hi:[1,0]
  v_pk_mul_f32 v[90:91], v[90:91], v[150:151] op_sel_hi:[1,0]
  v_pk_mul_f32 v[92:93], v[92:93], v[150:151] op_sel_hi:[1,0]
  v_pk_mul_f32 v[94:95], v[94:95], v[150:151] op_sel_hi:[1,0]
  v_cvt_pk_bf16_f32 v80, v80, v81
  v_cvt_pk_bf16_f32 v81, v82, v83
  v_cvt_pk_bf16_f32 v82, v84, v85
  v_cvt_pk_bf16_f32 v83, v86, v87
  v_cvt_pk_bf16_f32 v84, v88, v89
  v_cvt_pk_bf16_f32 v85, v90, v91
  v_cvt_pk_bf16_f32 v86, v92, v93
  v_cvt_pk_bf16_f32 v87, v94, v95
  buffer_store_dwordx2 v[80:81], v2, s[8:11], s26 offen offset:0 sc0 sc1
  buffer_store_dwordx2 v[82:83], v2, s[8:11], s26 offen offset:512 sc0 sc1
  buffer_store_dwordx2 v[84:85], v2, s[8:11], s26 offen offset:1024 sc0 sc1
  buffer_store_dwordx2 v[86:87], v2, s[8:11], s26 offen offset:1536 sc0 sc1
  s_branch L_gemm1_kernel_fin
L_gemm1_kernel_eph:
  s_mul_i32 s26, s26, 151552
  s_sub_u32 s3, s14, 4
  s_mul_i32 s3, s3, 10240
  s_add_u32 s26, s26, s3
  s_add_u32 s26, s26, 2883584
  v_lshlrev_b32 v2, 4, v1
  v_pk_mul_f32 v[16:17], v[16:17], v[150:151] op_sel_hi:[1,0]
  v_pk_mul_f32 v[18:19], v[18:19], v[150:151] op_sel_hi:[1,0]
  v_pk_mul_f32 v[20:21], v[20:21], v[150:151] op_sel_hi:[1,0]
  v_pk_mul_f32 v[22:23], v[22:23], v[150:151] op_sel_hi:[1,0]
  v_pk_mul_f32 v[24:25], v[24:25], v[150:151] op_sel_hi:[1,0]
  v_pk_mul_f32 v[26:27], v[26:27], v[150:151] op_sel_hi:[1,0]
  v_pk_mul_f32 v[28:29], v[28:29], v[150:151] op_sel_hi:[1,0]
  v_pk_mul_f32 v[30:31], v[30:31], v[150:151] op_sel_hi:[1,0]
  v_mul_f32_e64 v16, v16, |v16|
  v_mul_f32_e64 v17, v17, |v17|
  v_mul_f32_e64 v18, v18, |v18|
  v_mul_f32_e64 v19, v19, |v19|
  v_mul_f32_e64 v20, v20, |v20|
  v_mul_f32_e64 v21, v21, |v21|
  v_mul_f32_e64 v22, v22, |v22|
  v_mul_f32_e64 v23, v23, |v23|
  v_mul_f32_e64 v24, v24, |v24|
  v_mul_f32_e64 v25, v25, |v25|
  v_mul_f32_e64 v26, v26, |v26|
  v_mul_f32_e64 v27, v27, |v27|
  v_mul_f32_e64 v28, v28, |v28|
  v_mul_f32_e64 v29, v29, |v29|
  v_mul_f32_e64 v30, v30, |v30|
  v_mul_f32_e64 v31, v31, |v31|
  v_cvt_pk_bf16_f32 v16, v16, v17
  v_cvt_pk_bf16_f32 v17, v18, v19
  v_cvt_pk_bf16_f32 v18, v20, v21
  v_cvt_pk_bf16_f32 v19, v22, v23
  v_cvt_pk_bf16_f32 v20, v24, v25
  v_cvt_pk_bf16_f32 v21, v26, v27
  v_cvt_pk_bf16_f32 v22, v28, v29
  v_cvt_pk_bf16_f32 v23, v30, v31
  v_pk_max_i16 v16, v16, 0
  v_pk_max_i16 v17, v17, 0
  v_pk_max_i16 v18, v18, 0
  v_pk_max_i16 v19, v19, 0
  v_pk_max_i16 v20, v20, 0
  v_pk_max_i16 v21, v21, 0
  v_pk_max_i16 v22, v22, 0
  v_pk_max_i16 v23, v23, 0
  buffer_store_dwordx4 v[16:19], v2, s[8:11], s26 offen offset:0 sc0 sc1
  buffer_store_dwordx4 v[20:23], v2, s[8:11], s26 offen offset:1024 sc0 sc1
  v_pk_mul_f32 v[32:33], v[32:33], v[150:151] op_sel_hi:[1,0]
  v_pk_mul_f32 v[34:35], v[34:35], v[150:151] op_sel_hi:[1,0]
  v_pk_mul_f32 v[36:37], v[36:37], v[150:151] op_sel_hi:[1,0]
  v_pk_mul_f32 v[38:39], v[38:39], v[150:151] op_sel_hi:[1,0]
  v_pk_mul_f32 v[40:41], v[40:41], v[150:151] op_sel_hi:[1,0]
  v_pk_mul_f32 v[42:43], v[42:43], v[150:151] op_sel_hi:[1,0]
  v_pk_mul_f32 v[44:45], v[44:45], v[150:151] op_sel_hi:[1,0]
  v_pk_mul_f32 v[46:47], v[46:47], v[150:151] op_sel_hi:[1,0]
  v_mul_f32_e64 v32, v32, |v32|
  v_mul_f32_e64 v33, v33, |v33|
  v_mul_f32_e64 v34, v34, |v34|
  v_mul_f32_e64 v35, v35, |v35|
  v_mul_f32_e64 v36, v36, |v36|
  v_mul_f32_e64 v37, v37, |v37|
  v_mul_f32_e64 v38, v38, |v38|
  v_mul_f32_e64 v39, v39, |v39|
  v_mul_f32_e64 v40, v40, |v40|
  v_mul_f32_e64 v41, v41, |v41|
  v_mul_f32_e64 v42, v42, |v42|
  v_mul_f32_e64 v43, v43, |v43|
  v_mul_f32_e64 v44, v44, |v44|
  v_mul_f32_e64 v45, v45, |v45|
  v_mul_f32_e64 v46, v46, |v46|
  v_mul_f32_e64 v47, v47, |v47|
  v_cvt_pk_bf16_f32 v32, v32, v33
  v_cvt_pk_bf16_f32 v33, v34, v35
  v_cvt_pk_bf16_f32 v34, v36, v37
  v_cvt_pk_bf16_f32 v35, v38, v39
  v_cvt_pk_bf16_f32 v36, v40, v41
  v_cvt_pk_bf16_f32 v37, v42, v43
  v_cvt_pk_bf16_f32 v38, v44, v45
  v_cvt_pk_bf16_f32 v39, v46, v47
  v_pk_max_i16 v32, v32, 0
  v_pk_max_i16 v33, v33, 0
  v_pk_max_i16 v34, v34, 0
  v_pk_max_i16 v35, v35, 0
  v_pk_max_i16 v36, v36, 0
  v_pk_max_i16 v37, v37, 0
  v_pk_max_i16 v38, v38, 0
  v_pk_max_i16 v39, v39, 0
  buffer_store_dwordx4 v[32:35], v2, s[8:11], s26 offen offset:2048 sc0 sc1
  buffer_store_dwordx4 v[36:39], v2, s[8:11], s26 offen offset:3072 sc0 sc1
  s_add_u32 s26, s26, 4096
  v_pk_mul_f32 v[48:49], v[48:49], v[150:151] op_sel_hi:[1,0]
  v_pk_mul_f32 v[50:51], v[50:51], v[150:151] op_sel_hi:[1,0]
  v_pk_mul_f32 v[52:53], v[52:53], v[150:151] op_sel_hi:[1,0]
  v_pk_mul_f32 v[54:55], v[54:55], v[150:151] op_sel_hi:[1,0]
  v_pk_mul_f32 v[56:57], v[56:57], v[150:151] op_sel_hi:[1,0]
  v_pk_mul_f32 v[58:59], v[58:59], v[150:151] op_sel_hi:[1,0]
  v_pk_mul_f32 v[60:61], v[60:61], v[150:151] op_sel_hi:[1,0]
  v_pk_mul_f32 v[62:63], v[62:63], v[150:151] op_sel_hi:[1,0]
  v_mul_f32_e64 v48, v48, |v48|
  v_mul_f32_e64 v49, v49, |v49|
  v_mul_f32_e64 v50, v50, |v50|
  v_mul_f32_e64 v51, v51, |v51|
  v_mul_f32_e64 v52, v52, |v52|
  v_mul_f32_e64 v53, v53, |v53|
  v_mul_f32_e64 v54, v54, |v54|
  v_mul_f32_e64 v55, v55, |v55|
  v_mul_f32_e64 v56, v56, |v56|
  v_mul_f32_e64 v57, v57, |v57|
  v_mul_f32_e64 v58, v58, |v58|
  v_mul_f32_e64 v59, v59, |v59|
  v_mul_f32_e64 v60, v60, |v60|
  v_mul_f32_e64 v61, v61, |v61|
  v_mul_f32_e64 v62, v62, |v62|
  v_mul_f32_e64 v63, v63, |v63|
  v_cvt_pk_bf16_f32 v48, v48, v49
  v_cvt_pk_bf16_f32 v49, v50, v51
  v_cvt_pk_bf16_f32 v50, v52, v53
  v_cvt_pk_bf16_f32 v51, v54, v55
  v_cvt_pk_bf16_f32 v52, v56, v57
  v_cvt_pk_bf16_f32 v53, v58, v59
  v_cvt_pk_bf16_f32 v54, v60, v61
  v_cvt_pk_bf16_f32 v55, v62, v63
  v_pk_max_i16 v48, v48, 0
  v_pk_max_i16 v49, v49, 0
  v_pk_max_i16 v50, v50, 0
  v_pk_max_i16 v51, v51, 0
  v_pk_max_i16 v52, v52, 0
  v_pk_max_i16 v53, v53, 0
  v_pk_max_i16 v54, v54, 0
  v_pk_max_i16 v55, v55, 0
  buffer_store_dwordx4 v[48:51], v2, s[8:11], s26 offen offset:0 sc0 sc1
  buffer_store_dwordx4 v[52:55], v2, s[8:11], s26 offen offset:1024 sc0 sc1
  v_pk_mul_f32 v[64:65], v[64:65], v[150:151] op_sel_hi:[1,0]
  v_pk_mul_f32 v[66:67], v[66:67], v[150:151] op_sel_hi:[1,0]
  v_pk_mul_f32 v[68:69], v[68:69], v[150:151] op_sel_hi:[1,0]
  v_pk_mul_f32 v[70:71], v[70:71], v[150:151] op_sel_hi:[1,0]
  v_pk_mul_f32 v[72:73], v[72:73], v[150:151] op_sel_hi:[1,0]
  v_pk_mul_f32 v[74:75], v[74:75], v[150:151] op_sel_hi:[1,0]
  v_pk_mul_f32 v[76:77], v[76:77], v[150:151] op_sel_hi:[1,0]
  v_pk_mul_f32 v[78:79], v[78:79], v[150:151] op_sel_hi:[1,0]
  v_mul_f32_e64 v64, v64, |v64|
  v_mul_f32_e64 v65, v65, |v65|
  v_mul_f32_e64 v66, v66, |v66|
  v_mul_f32_e64 v67, v67, |v67|
  v_mul_f32_e64 v68, v68, |v68|
  v_mul_f32_e64 v69, v69, |v69|
  v_mul_f32_e64 v70, v70, |v70|
  v_mul_f32_e64 v71, v71, |v71|
  v_mul_f32_e64 v72, v72, |v72|
  v_mul_f32_e64 v73, v73, |v73|
  v_mul_f32_e64 v74, v74, |v74|
  v_mul_f32_e64 v75, v75, |v75|
  v_mul_f32_e64 v76, v76, |v76|
  v_mul_f32_e64 v77, v77, |v77|
  v_mul_f32_e64 v78, v78, |v78|
  v_mul_f32_e64 v79, v79, |v79|
  v_cvt_pk_bf16_f32 v64, v64, v65
  v_cvt_pk_bf16_f32 v65, v66, v67
  v_cvt_pk_bf16_f32 v66, v68, v69
  v_cvt_pk_bf16_f32 v67, v70, v71
  v_cvt_pk_bf16_f32 v68, v72, v73
  v_cvt_pk_bf16_f32 v69, v74, v75
  v_cvt_pk_bf16_f32 v70, v76, v77
  v_cvt_pk_bf16_f32 v71, v78, v79
  v_pk_max_i16 v64, v64, 0
  v_pk_max_i16 v65, v65, 0
  v_pk_max_i16 v66, v66, 0
  v_pk_max_i16 v67, v67, 0
  v_pk_max_i16 v68, v68, 0
  v_pk_max_i16 v69, v69, 0
  v_pk_max_i16 v70, v70, 0
  v_pk_max_i16 v71, v71, 0
  buffer_store_dwordx4 v[64:67], v2, s[8:11], s26 offen offset:2048 sc0 sc1
  buffer_store_dwordx4 v[68:71], v2, s[8:11], s26 offen offset:3072 sc0 sc1
  s_add_u32 s26, s26, 4096
  s_cmp_eq_u32 s14, 14
  s_cbranch_scc1 L_gemm1_kernel_fin
  v_pk_mul_f32 v[80:81], v[80:81], v[150:151] op_sel_hi:[1,0]
  v_pk_mul_f32 v[82:83], v[82:83], v[150:151] op_sel_hi:[1,0]
  v_pk_mul_f32 v[84:85], v[84:85], v[150:151] op_sel_hi:[1,0]
  v_pk_mul_f32 v[86:87], v[86:87], v[150:151] op_sel_hi:[1,0]
  v_pk_mul_f32 v[88:89], v[88:89], v[150:151] op_sel_hi:[1,0]
  v_pk_mul_f32 v[90:91], v[90:91], v[150:151] op_sel_hi:[1,0]
  v_pk_mul_f32 v[92:93], v[92:93], v[150:151] op_sel_hi:[1,0]
  v_pk_mul_f32 v[94:95], v[94:95], v[150:151] op_sel_hi:[1,0]
  v_mul_f32_e64 v80, v80, |v80|
  v_mul_f32_e64 v81, v81, |v81|
  v_mul_f32_e64 v82, v82, |v82|
  v_mul_f32_e64 v83, v83, |v83|
  v_mul_f32_e64 v84, v84, |v84|
  v_mul_f32_e64 v85, v85, |v85|
  v_mul_f32_e64 v86, v86, |v86|
  v_mul_f32_e64 v87, v87, |v87|
  v_mul_f32_e64 v88, v88, |v88|
  v_mul_f32_e64 v89, v89, |v89|
  v_mul_f32_e64 v90, v90, |v90|
  v_mul_f32_e64 v91, v91, |v91|
  v_mul_f32_e64 v92, v92, |v92|
  v_mul_f32_e64 v93, v93, |v93|
  v_mul_f32_e64 v94, v94, |v94|
  v_mul_f32_e64 v95, v95, |v95|
  v_cvt_pk_bf16_f32 v80, v80, v81
  v_cvt_pk_bf16_f32 v81, v82, v83
  v_cvt_pk_bf16_f32 v82, v84, v85
  v_cvt_pk_bf16_f32 v83, v86, v87
  v_cvt_pk_bf16_f32 v84, v88, v89
  v_cvt_pk_bf16_f32 v85, v90, v91
  v_cvt_pk_bf16_f32 v86, v92, v93
  v_cvt_pk_bf16_f32 v87, v94, v95
  v_pk_max_i16 v80, v80, 0
  v_pk_max_i16 v81, v81, 0
  v_pk_max_i16 v82, v82, 0
  v_pk_max_i16 v83, v83, 0
  v_pk_max_i16 v84, v84, 0
  v_pk_max_i16 v85, v85, 0
  v_pk_max_i16 v86, v86, 0
  v_pk_max_i16 v87, v87, 0
  buffer_store_dwordx4 v[80:83], v2, s[8:11], s26 offen offset:0 sc0 sc1
  buffer_store_dwordx4 v[84:87], v2, s[8:11], s26 offen offset:1024 sc0 sc1
  s_branch L_gemm1_kernel_fin
L_gemm1_kernel_ckv:
  v_lshrrev_b32 v2, 5, v1
  v_bfe_u32 v3, v1, 2, 2
  v_lshl_add_u32 v2, v2, 3, v3
  v_mul_u32_u24 v2, 40, v2
  v_bfe_u32 v3, v1, 4, 1
  v_lshl_add_u32 v2, v3, 5, v2
  v_and_b32 v3, 3, v1
  v_lshl_add_u32 v4, v3, 3, v2
  s_add_u32 s3, s12, 0
  s_and_b32 s3, s3, 3
  s_mul_i32 s3, s3, 640
  s_add_u32 s3, s3, 65536
  v_add_u32 v180, s3, v4
  v_mov_b32 v184, v180
  s_add_u32 s3, s12, 1
  s_and_b32 s3, s3, 3
  s_mul_i32 s3, s3, 640
  s_add_u32 s3, s3, 65536
  v_add_u32 v181, s3, v4
  v_mov_b32 v185, v181
  s_add_u32 s3, s12, 2
  s_and_b32 s3, s3, 3
  s_mul_i32 s3, s3, 640
  s_add_u32 s3, s3, 65536
  v_add_u32 v182, s3, v4
  v_mov_b32 v186, v182
  s_add_u32 s3, s12, 3
  s_and_b32 s3, s3, 3
  s_mul_i32 s3, s3, 640
  s_add_u32 s3, s3, 65536
  v_add_u32 v183, s3, v4
  v_mov_b32 v187, v183
  s_cmp_eq_u32 s12, 0
  s_cselect_b32 s63, 2, 99
  s_barrier
  ds_read_b128 v[96:99], v12
  ds_read_b64_tr_b16 v[100:101], v184 offset:0
  ds_read_b64_tr_b16 v[102:103], v184 offset:160
  ds_read_b64_tr_b16 v[104:105], v184 offset:26624
  ds_read_b64_tr_b16 v[106:107], v184 offset:26784
  .p2align 6
L_gemm1_kernel_kloop:
  s_waitcnt lgkmcnt(2)
  v_mfma_f32_32x32x16_bf16 v[16:31], v[100:103], v[96:99], v[16:31]
  ds_read_b128 v[120:123], v13
  ds_read_b64_tr_b16 v[124:125], v185 offset:0
  ds_read_b64_tr_b16 v[126:127], v185 offset:160
  ds_read_b64_tr_b16 v[128:129], v185 offset:26624
  ds_read_b64_tr_b16 v[130:131], v185 offset:26784
  s_waitcnt lgkmcnt(5)
  v_mfma_f32_32x32x16_bf16 v[32:47], v[104:107], v[96:99], v[32:47]
  v_add_u32 v14, s20, v10
  v_add_u32 v186, s21, v182
  v_add_u32 v15, s20, v11
  v_add_u32 v187, s21, v183
  v_mfma_f32_16x16x32_bf16 v[160:163], v[156:159], v[100:103], v[160:163]
  v_mfma_f32_16x16x32_bf16 v[164:167], v[156:159], v[104:107], v[164:167]
  s_waitcnt lgkmcnt(2)
  v_mfma_f32_32x32x16_bf16 v[16:31], v[124:127], v[120:123], v[16:31]
  ds_read_b128 v[96:99], v14
  ds_read_b64_tr_b16 v[100:101], v186 offset:0
  ds_read_b64_tr_b16 v[102:103], v186 offset:160
  ds_read_b64_tr_b16 v[104:105], v186 offset:26624
  ds_read_b64_tr_b16 v[106:107], v186 offset:26784
  s_waitcnt lgkmcnt(5)
  v_mfma_f32_32x32x16_bf16 v[32:47], v[128:131], v[120:123], v[32:47]
  s_cmp_eq_u32 s22, s63
  s_cbranch_scc1 L_gemm1_kernel_kpub
L_gemm1_kernel_kpubret:
  s_waitcnt lgkmcnt(2)
  v_mfma_f32_32x32x16_bf16 v[16:31], v[100:103], v[96:99], v[16:31]
  ds_read_b128 v[120:123], v15
  ds_read_b64_tr_b16 v[124:125], v187 offset:0
  ds_read_b64_tr_b16 v[126:127], v187 offset:160
  ds_read_b64_tr_b16 v[128:129], v187 offset:26624
  ds_read_b64_tr_b16 v[130:131], v187 offset:26784
  s_waitcnt lgkmcnt(5)
  v_mfma_f32_32x32x16_bf16 v[32:47], v[104:107], v[96:99], v[32:47]
  s_add_u32 s20, s20, 16384
  s_and_b32 s20, s20, 65535
  s_add_u32 s21, s21, 2560
  s_waitcnt lgkmcnt(2)
  v_mfma_f32_32x32x16_bf16 v[16:31], v[124:127], v[120:123], v[16:31]
  v_add_u32 v12, s20, v8
  v_add_u32 v184, s21, v180
  v_add_u32 v13, s20, v9
  v_add_u32 v185, s21, v181
  s_add_u32 s22, s22, 1
  s_cmp_eq_u32 s22, 10
  s_waitcnt lgkmcnt(0)
  s_cbranch_scc1 L_gemm1_kernel_knobar
  s_barrier
L_gemm1_kernel_knobar:
  ds_read_b128 v[96:99], v12
  ds_read_b64_tr_b16 v[100:101], v184 offset:0
  ds_read_b64_tr_b16 v[102:103], v184 offset:160
  ds_read_b64_tr_b16 v[104:105], v184 offset:26624
  ds_read_b64_tr_b16 v[106:107], v184 offset:26784
  v_mfma_f32_32x32x16_bf16 v[32:47], v[128:131], v[120:123], v[32:47]
  s_cbranch_scc0 L_gemm1_kernel_kloop
  s_branch L_gemm1_kernel_kdone
L_gemm1_kernel_kpub:
  s_lshl_b32 s3, s13, 4
  s_add_u32 s3, s3, s14
  v_mov_b32 v2, 0
  v_mov_b32 v3, 1
  s_mov_b64 exec, 1
  s_waitcnt vmcnt(0)
  buffer_store_byte v3, v2, s[64:67], s3 offen sc0 sc1
  s_mov_b64 exec, -1
  s_branch L_gemm1_kernel_kpubret
L_gemm1_kernel_kdone:
  s_waitcnt lgkmcnt(0)
  v_and_b32 v2, 31, v1
  s_lshl_b32 s3, s12, 2
  s_add_u32 s3, s3, 151552
  v_lshl_add_u32 v5, v2, 4, s3
  v_lshlrev_b32 v3, 4, v2
  v_add_u32 v4, 151552, v3
  v_cndmask_b32 v144, v160, v161, s[60:61]
  v_cndmask_b32 v145, v164, v165, s[60:61]
  v_and_b32 v96, 0xffff0000, v144
  v_and_b32 v97, 0xffff0000, v145
  v_sub_f32 v144, v144, v96
  v_sub_f32 v145, v145, v97
  v_cvt_pk_bf16_f32 v144, v96, v144
  v_cvt_pk_bf16_f32 v145, v97, v145
  ds_write_b32 v5, v144 offset:0
  ds_write_b32 v5, v145 offset:512
  v_add_u32 v3, 147456, v3
  v_cndmask_b32 v3, v4, v3, s[24:25]
  s_lshl_b32 s3, s12, 7
  s_add_u32 s3, s3, 155648
  v_lshl_add_u32 v2, v2, 2, s3
  s_waitcnt lgkmcnt(0)
  s_barrier
  ds_read_b32 v5, v2
  ds_read_b128 v[124:127], v3 offset:0
  ds_read_b128 v[128:131], v3 offset:512
  s_waitcnt lgkmcnt(2)
  v_and_b32 v2, 0xffff, v5
  v_lshl_or_b32 v2, v2, 16, v2
  v_lshrrev_b32 v3, 16, v5
  v_and_b32 v150, 0xffff0000, v5
  v_rcp_f32 v150, v150
  v_cndmask_b32 v120, v2, v3, s[24:25]
  v_cndmask_b32 v121, v2, 0, s[24:25]
  v_cndmask_b32 v122, v2, 0, s[24:25]
  v_cndmask_b32 v123, v2, 0, s[24:25]
  s_waitcnt lgkmcnt(0)
  s_nop 0
  v_mfma_f32_32x32x16_bf16 v[16:31], v[124:127], v[120:123], v[16:31]
  v_mfma_f32_32x32x16_bf16 v[32:47], v[128:131], v[120:123], v[32:47]
  s_lshl_b32 s26, s13, 2
  s_add_u32 s26, s26, s12
  s_nop 9
  s_mul_i32 s26, s26, 2688
  s_add_u32 s26, s26, 2621440
  v_lshlrev_b32 v2, 4, v1
  v_lshlrev_b32 v3, 3, v1
  v_bfe_u32 v5, v1, 3, 2
  v_mul_u32_u24 v5, 352, v5
  v_and_b32 v6, 7, v1
  v_lshl_add_u32 v5, v6, 1, v5
  v_lshrrev_b32 v6, 5, v1
  v_lshl_add_u32 v5, v6, 6, v5
  v_mul_f32 v16, v150, v16
  v_mul_f32 v32, v150, v32
  v_mul_f32 v17, v150, v17
  v_mul_f32 v33, v150, v33
  v_mul_f32 v18, v150, v18
  v_mul_f32 v34, v150, v34
  v_mul_f32 v19, v150, v19
  v_mul_f32 v35, v150, v35
  v_mul_f32 v20, v150, v20
  v_mul_f32 v36, v150, v36
  v_mul_f32 v21, v150, v21
  v_mul_f32 v37, v150, v37
  v_mul_f32 v22, v150, v22
  v_mul_f32 v38, v150, v38
  v_mul_f32 v23, v150, v23
  v_mul_f32 v39, v150, v39
  v_mul_f32 v24, v150, v24
  v_mul_f32 v40, v150, v40
  v_mul_f32 v25, v150, v25
  v_mul_f32 v41, v150, v41
  v_mul_f32 v26, v150, v26
  v_mul_f32 v42, v150, v42
  v_mul_f32 v27, v150, v27
  v_mul_f32 v43, v150, v43
  v_cndmask_b32 v40, v40, 1.0, s[24:25]
  v_cndmask_b32 v41, v41, 0, s[24:25]
  v_cvt_pk_bf16_f32 v16, v16, v17
  v_cvt_pk_bf16_f32 v32, v32, v33
  v_cvt_pk_bf16_f32 v17, v18, v19
  v_cvt_pk_bf16_f32 v33, v34, v35
  v_cvt_pk_bf16_f32 v18, v20, v21
  v_cvt_pk_bf16_f32 v34, v36, v37
  v_cvt_pk_bf16_f32 v19, v22, v23
  v_cvt_pk_bf16_f32 v35, v38, v39
  v_cvt_pk_bf16_f32 v20, v24, v25
  v_cvt_pk_bf16_f32 v36, v40, v41
  v_cvt_pk_bf16_f32 v21, v26, v27
  v_cvt_pk_bf16_f32 v37, v42, v43
  buffer_store_dwordx4 v[16:19], v2, s[8:11], s26 offen
  buffer_store_short v32, v5, s[8:11], s26 offen offset:1280
  buffer_store_short_d16_hi v32, v5, s[8:11], s26 offen offset:1296
  buffer_store_short v33, v5, s[8:11], s26 offen offset:1312
  buffer_store_short_d16_hi v33, v5, s[8:11], s26 offen offset:1328
  buffer_store_short v34, v5, s[8:11], s26 offen offset:1408
  buffer_store_short_d16_hi v34, v5, s[8:11], s26 offen offset:1424
  buffer_store_short v35, v5, s[8:11], s26 offen offset:1440
  buffer_store_short_d16_hi v35, v5, s[8:11], s26 offen offset:1456
  buffer_store_short v36, v5, s[8:11], s26 offen offset:1536
  buffer_store_short_d16_hi v36, v5, s[8:11], s26 offen offset:1552
  s_mov_b32 exec_hi, 0
  buffer_store_dwordx2 v[20:21], v3, s[8:11], s26 offen offset:1024
  buffer_store_short v37, v5, s[8:11], s26 offen offset:1568
  buffer_store_short_d16_hi v37, v5, s[8:11], s26 offen offset:1584
  s_branch L_gemm1_kernel_fin
L_gemm1_kernel_fin:
L_gemm1_kernel_end:
  s_endpgm
.section .rodata,"a"
.p2align 6
.amdhsa_kernel gemm1_kernel
  .amdhsa_next_free_vgpr 188
  .amdhsa_next_free_sgpr 96
  .amdhsa_accum_offset 188
  .amdhsa_group_segment_fixed_size 0
  .amdhsa_kernarg_size 104
  .amdhsa_user_sgpr_count 2
  .amdhsa_user_sgpr_kernarg_segment_ptr 1
  .amdhsa_system_sgpr_workgroup_id_x 1
.end_amdhsa_kernel
.text
.globl k2_kernel
.p2align 8
.type k2_kernel,@function
k2_kernel:
  s_cmp_ge_u32 s2, 256
  s_cbranch_scc1 L_k2_kernel_end
  s_load_dwordx2 s[4:5], s[0:1], 96
  s_load_dwordx2 s[36:37], s[0:1], 0
  s_load_dwordx4 s[40:43], s[0:1], 72
  v_lshrrev_b32 v5, 6, v0
  v_and_b32 v4, 63, v0
  s_and_b32 s6, s2, 7
  s_lshr_b32 s7, s2, 3
  v_readfirstlane_b32 s12, v5
  s_lshl_b32 s6, s6, 2
  s_lshr_b32 s3, s7, 3
  s_add_u32 s21, s6, s3
  s_and_b32 s26, s7, 7
  v_lshlrev_b32 v3, 4, v4
  s_mov_b32 s19, 0
  s_cmp_ge_u32 s12, 8
  s_cbranch_scc1 L_k2_kernel_gemm
  s_lshr_b32 s13, s12, 2
  s_and_b32 s3, s12, 1
  s_lshl_b32 s14, s21, 1
  s_add_u32 s14, s14, s3
  s_lshl_b32 s15, s26, 2
  s_and_b32 s3, s12, 2
  s_add_u32 s15, s15, s3
  s_mul_i32 s16, s14, 40960
  s_add_u32 s15, s15, s13
  s_mul_i32 s3, s15, 1280
  s_add_u32 s27, s16, s3
  s_xor_b32 s3, s15, 1
  s_mul_i32 s3, s3, 1280
  s_add_u32 s16, s16, s3
  s_mov_b32 s22, 0
  s_mov_b32 s23, -1
  v_lshlrev_b32 v6, 3, v4
  s_waitcnt lgkmcnt(0)
  s_mov_b32 s8, s4
  s_mov_b32 s9, s5
  s_mov_b32 s10, 0x1000000
  s_mov_b32 s11, 0x00020000
  buffer_load_dwordx2 v[112:113], v6, s[8:11], s16 offen
  buffer_load_dwordx2 v[114:115], v6, s[8:11], s16 offen offset:512
  buffer_load_dwordx2 v[116:117], v6, s[8:11], s16 offen offset:1024
  buffer_load_dwordx2 v[120:121], v6, s[8:11], s27 offen
  buffer_load_dwordx2 v[122:123], v6, s[8:11], s27 offen offset:512
  buffer_load_dwordx2 v[124:125], v6, s[8:11], s27 offen offset:1024
  s_mul_i32 s3, s13, 10752
  v_add_u32 v127, s3, v3
  v_and_b32 v5, 31, v4
  v_lshlrev_b32 v1, 3, v5
  v_add_u32 v1, s3, v1
  v_min_u32 v7, 21, v5
  v_lshrrev_b32 v9, 5, v4
  v_mov_b32 v126, 0xdddddddd
  v_lshlrev_b32 v7, 4, v7
  v_mul_u32_u24 v9, 352, v9
  v_add3_u32 v2, v7, v9, s3
  s_add_u32 s3, s3, 576
  v_mov_b32 v7, s3
  v_cndmask_b32 v1, v1, v7, s[22:23]
  s_and_b32 s3, s15, 3
  s_mul_i32 s3, s3, 5
  v_lshrrev_b32 v8, 5, v4
  v_add_u32 v8, s3, v8
  s_and_b32 s3, s12, 1
  s_mul_i32 s3, s3, 5120
  v_lshl_add_u32 v9, v5, 4, s3
  s_lshl_b32 s27, s21, 1
  s_mul_i32 s27, s27, 151552
  s_mul_i32 s3, s26, 5120
  s_add_u32 s27, s27, s3
  s_add_u32 s27, s27, 2994176
  s_lshl_b32 s3, s12, 10
  v_add_u32 v145, s3, v3
  s_add_u32 s28, s27, 154624
  s_add_u32 s28, s28, s3
  s_cmp_lt_u32 s12, 2
  s_cselect_b32 s28, s28, 0x40000000
  s_add_u32 s27, s27, s3
  s_cmp_ge_u32 s12, 5
  s_cselect_b32 s3, 146432, 0
  s_add_u32 s27, s27, s3
  s_mul_i32 s3, s12, 3328
  v_add_u32 v143, s3, v3
  s_xor_b32 s3, s12, 4
  s_mul_i32 s3, s3, 3328
  v_add_u32 v144, s3, v3
  v_lshrrev_b32 v140, 2, v8
  v_lshl_add_u32 v140, v140, 10, v9
  v_and_b32 v7, 1, v8
  v_lshl_add_u32 v140, v7, 9, v140
  v_and_b32 v7, 2, v8
  v_lshl_add_u32 v140, v7, 2, v140
  v_add_u32 v8, 2, v8
  v_lshrrev_b32 v141, 2, v8
  v_lshl_add_u32 v141, v141, 10, v9
  v_and_b32 v7, 1, v8
  v_lshl_add_u32 v141, v7, 9, v141
  v_and_b32 v7, 2, v8
  v_lshl_add_u32 v141, v7, 2, v141
  v_add_u32 v8, 2, v8
  v_lshrrev_b32 v142, 2, v8
  v_lshl_add_u32 v142, v142, 10, v9
  v_and_b32 v7, 1, v8
  v_lshl_add_u32 v142, v7, 9, v142
  v_and_b32 v7, 2, v8
  v_lshl_add_u32 v142, v7, 2, v142
  v_add_u32 v8, 2, v8
L_k2_kernel_start:
  v_mov_b32 v48, 0
  v_mov_b32 v64, 0
  v_mov_b32 v49, 0
  v_mov_b32 v65, 0
  v_mov_b32 v50, 0
  v_mov_b32 v66, 0
  v_mov_b32 v51, 0
  v_mov_b32 v67, 0
  v_mov_b32 v52, 0
  v_mov_b32 v68, 0
  v_mov_b32 v53, 0
  v_mov_b32 v69, 0
  v_mov_b32 v54, 0
  v_mov_b32 v70, 0
  v_mov_b32 v55, 0
  v_mov_b32 v71, 0
  v_mov_b32 v56, 0
  v_mov_b32 v72, 0
  v_mov_b32 v57, 0
  v_mov_b32 v73, 0
  v_mov_b32 v58, 0
  v_mov_b32 v74, 0
  v_mov_b32 v59, 0
  v_mov_b32 v75, 0
  v_mov_b32 v60, 0
  v_mov_b32 v76, 0
  v_mov_b32 v61, 0
  v_mov_b32 v77, 0
  v_mov_b32 v62, 0
  v_mov_b32 v78, 0
  v_mov_b32 v63, 0
  v_mov_b32 v79, 0
  s_waitcnt vmcnt(0)
  s_barrier
  s_cmp_lg_u32 s19, 0
  s_cbranch_scc1 L_k2_kernel_init
  ds_read_b128 v[128:131], v127 offset:0
  ds_read_b64 v[118:119], v1 offset:1024
  ds_read_b128 v[132:135], v127 offset:2688
  ds_read_b64 v[136:137], v1 offset:3712
  s_mov_b64 exec, s[22:23]
  v_mov_b32 v116, 0
  v_mov_b32 v117, 0
  v_mov_b32 v124, 0
  v_mov_b32 v125, 0
  s_mov_b64 exec, -1
  s_waitcnt lgkmcnt(2)
  v_mfma_f32_32x32x16_bf16 v[16:31], v[128:131], v[112:115], 0
  v_mfma_f32_32x32x8_bf16 v[16:31], v[118:119], v[116:117], v[16:31]
  v_mfma_f32_32x32x16_bf16 v[32:47], v[128:131], v[120:123], 0
  v_mfma_f32_32x32x8_bf16 v[32:47], v[118:119], v[124:125], v[32:47]
  s_waitcnt lgkmcnt(0)
  v_mfma_f32_32x32x16_bf16 v[80:95], v[132:135], v[112:115], 0
  v_mfma_f32_32x32x8_bf16 v[80:95], v[136:137], v[116:117], v[80:95]
  v_mfma_f32_32x32x16_bf16 v[96:111], v[132:135], v[120:123], 0
  v_mfma_f32_32x32x8_bf16 v[96:111], v[136:137], v[124:125], v[96:111]
  s_nop 7
  v_max3_f32 v5, v16, v17, v18
  v_max_f32 v5, v5, v19
  v_max3_f32 v5, v5, v20, v21
  v_max3_f32 v5, v5, v22, v23
  v_max3_f32 v5, v5, v24, v25
  v_max3_f32 v5, v5, v26, v27
  v_max3_f32 v5, v5, v28, v29
  v_max3_f32 v5, v5, v30, v31
  v_max3_f32 v6, v32, v33, v34
  v_max_f32 v6, v6, v35
  v_max3_f32 v6, v6, v36, v37
  v_max3_f32 v6, v6, v38, v39
  v_max3_f32 v6, v6, v40, v41
  v_max3_f32 v6, v6, v42, v43
  v_max3_f32 v6, v6, v44, v45
  v_max3_f32 v6, v6, v46, v47
  s_nop 3
  v_max3_f32 v5, v5, v80, v81
  v_max3_f32 v5, v5, v82, v83
  v_max3_f32 v5, v5, v84, v85
  v_max3_f32 v5, v5, v86, v87
  v_max3_f32 v5, v5, v88, v89
  v_max3_f32 v5, v5, v90, v91
  v_max3_f32 v5, v5, v92, v93
  v_max3_f32 v5, v5, v94, v95
  v_max3_f32 v6, v6, v96, v97
  v_max3_f32 v6, v6, v98, v99
  v_max3_f32 v6, v6, v100, v101
  v_max3_f32 v6, v6, v102, v103
  v_max3_f32 v6, v6, v104, v105
  v_max3_f32 v6, v6, v106, v107
  v_max3_f32 v6, v6, v108, v109
  v_max3_f32 v6, v6, v110, v111
  v_mov_b32 v7, v5
  s_nop 1
  v_permlane32_swap_b32 v5, v7
  s_nop 1
  v_max_f32 v5, v5, v7
  v_sub_f32 v80, 0xc2a00000, v5
  v_and_b32 v7, 0xffff0000, v80
  v_sub_f32 v8, v80, v7
  v_and_b32 v9, 0xffff0000, v8
  v_sub_f32 v8, v8, v9
  v_lshrrev_b32 v7, 16, v7
  v_or_b32 v7, v7, v9
  v_lshrrev_b32 v8, 16, v8
  v_cndmask_b32 v116, v116, v7, s[22:23]
  v_cndmask_b32 v117, v117, v8, s[22:23]
  v_mov_b32 v7, v6
  s_nop 1
  v_permlane32_swap_b32 v6, v7
  s_nop 1
  v_max_f32 v6, v6, v7
  v_sub_f32 v96, 0xc2a00000, v6
  v_and_b32 v7, 0xffff0000, v96
  v_sub_f32 v8, v96, v7
  v_and_b32 v9, 0xffff0000, v8
  v_sub_f32 v8, v8, v9
  v_lshrrev_b32 v7, 16, v7
  v_or_b32 v7, v7, v9
  v_lshrrev_b32 v8, 16, v8
  v_cndmask_b32 v124, v124, v7, s[22:23]
  v_cndmask_b32 v125, v125, v8, s[22:23]
L_k2_kernel_init:
  ds_read_b128 v[128:131], v127 offset:0
  ds_read_b64 v[118:119], v1 offset:1024
  ds_read_b128 v[132:135], v2 offset:1280
  v_mov_b32 v40, 0
  v_mov_b32 v41, 0
  v_mov_b32 v42, 0
  v_mov_b32 v43, 0
  v_mov_b32 v44, 0
  v_mov_b32 v45, 0
  v_mov_b32 v46, 0
  v_mov_b32 v47, 0
  v_mov_b32 v136, 0
  v_mov_b32 v137, 0
  v_mov_b32 v138, 0
  v_mov_b32 v139, 0
  s_waitcnt lgkmcnt(0)
  v_mfma_f32_32x32x16_bf16 v[16:31], v[128:131], v[112:115], 0
  v_mfma_f32_32x32x8_bf16 v[16:31], v[118:119], v[116:117], v[16:31]
  s_mov_b32 s20, 0
  s_nop 15
  .p2align 6
L_k2_kernel_loop:
  v_exp_f32 v16, v16
  v_exp_f32 v17, v17
  v_smfmac_f32_32x32x32_bf16 v[64:79], v[136:139], v[40:47], v126
  ds_read_b128 v[136:139], v2 offset:1984
  v_exp_f32 v18, v18
  v_exp_f32 v19, v19
  v_exp_f32 v20, v20
  v_mfma_f32_32x32x16_bf16 v[32:47], v[128:131], v[120:123], 0
  v_exp_f32 v21, v21
  v_exp_f32 v22, v22
  v_exp_f32 v23, v23
  v_mfma_f32_32x32x8_bf16 v[32:47], v[118:119], v[124:125], v[32:47]
  ds_read_b128 v[128:131], v127 offset:2688
  ds_read_b64 v[118:119], v1 offset:3712
  v_exp_f32 v24, v24
  v_exp_f32 v25, v25
  v_exp_f32 v26, v26
  v_exp_f32 v27, v27
  s_waitcnt lgkmcnt(3)
  v_smfmac_f32_32x32x32_bf16 v[48:63], v[132:135], v[16:23], v126
  v_exp_f32 v28, v28
  v_exp_f32 v29, v29
  v_exp_f32 v30, v30
  v_exp_f32 v31, v31
  v_exp_f32 v32, v32
  v_exp_f32 v33, v33
  s_waitcnt lgkmcnt(2)
  v_smfmac_f32_32x32x32_bf16 v[48:63], v[136:139], v[24:31], v126
  v_exp_f32 v34, v34
  v_exp_f32 v35, v35
  v_exp_f32 v36, v36
  s_waitcnt lgkmcnt(0)
  v_mfma_f32_32x32x16_bf16 v[16:31], v[128:131], v[112:115], 0
  v_exp_f32 v37, v37
  v_exp_f32 v38, v38
  v_exp_f32 v39, v39
  v_mfma_f32_32x32x8_bf16 v[16:31], v[118:119], v[116:117], v[16:31]
  v_exp_f32 v40, v40
  v_exp_f32 v41, v41
  v_exp_f32 v42, v42
  v_exp_f32 v43, v43
  v_smfmac_f32_32x32x32_bf16 v[64:79], v[132:135], v[32:39], v126
  ds_read_b128 v[132:135], v2 offset:3968
  v_exp_f32 v44, v44
  v_exp_f32 v45, v45
  v_exp_f32 v46, v46
  v_exp_f32 v47, v47
  v_exp_f32 v16, v16
  v_exp_f32 v17, v17
  v_smfmac_f32_32x32x32_bf16 v[64:79], v[136:139], v[40:47], v126
  ds_read_b128 v[136:139], v2 offset:4672
  v_exp_f32 v18, v18
  v_exp_f32 v19, v19
  v_exp_f32 v20, v20
  v_mfma_f32_32x32x16_bf16 v[32:47], v[128:131], v[120:123], 0
  v_exp_f32 v21, v21
  v_exp_f32 v22, v22
  v_exp_f32 v23, v23
  v_mfma_f32_32x32x8_bf16 v[32:47], v[118:119], v[124:125], v[32:47]
  ds_read_b128 v[128:131], v127 offset:5376
  ds_read_b64 v[118:119], v1 offset:6400
  v_exp_f32 v24, v24
  v_exp_f32 v25, v25
  v_exp_f32 v26, v26
  v_exp_f32 v27, v27
  s_waitcnt lgkmcnt(3)
  v_smfmac_f32_32x32x32_bf16 v[48:63], v[132:135], v[16:23], v126
  v_exp_f32 v28, v28
  v_exp_f32 v29, v29
  v_exp_f32 v30, v30
  v_exp_f32 v31, v31
  v_exp_f32 v32, v32
  v_exp_f32 v33, v33
  s_waitcnt lgkmcnt(2)
  v_smfmac_f32_32x32x32_bf16 v[48:63], v[136:139], v[24:31], v126
  v_exp_f32 v34, v34
  v_exp_f32 v35, v35
  v_exp_f32 v36, v36
  s_waitcnt lgkmcnt(0)
  v_mfma_f32_32x32x16_bf16 v[16:31], v[128:131], v[112:115], 0
  v_exp_f32 v37, v37
  v_exp_f32 v38, v38
  v_exp_f32 v39, v39
  v_mfma_f32_32x32x8_bf16 v[16:31], v[118:119], v[116:117], v[16:31]
  v_exp_f32 v40, v40
  v_exp_f32 v41, v41
  v_exp_f32 v42, v42
  v_exp_f32 v43, v43
  v_smfmac_f32_32x32x32_bf16 v[64:79], v[132:135], v[32:39], v126
  ds_read_b128 v[132:135], v2 offset:6656
  v_exp_f32 v44, v44
  v_exp_f32 v45, v45
  v_exp_f32 v46, v46
  v_exp_f32 v47, v47
  v_exp_f32 v16, v16
  v_exp_f32 v17, v17
  v_smfmac_f32_32x32x32_bf16 v[64:79], v[136:139], v[40:47], v126
  ds_read_b128 v[136:139], v2 offset:7360
  v_exp_f32 v18, v18
  v_exp_f32 v19, v19
  v_exp_f32 v20, v20
  v_mfma_f32_32x32x16_bf16 v[32:47], v[128:131], v[120:123], 0
  v_exp_f32 v21, v21
  v_exp_f32 v22, v22
  v_exp_f32 v23, v23
  v_mfma_f32_32x32x8_bf16 v[32:47], v[118:119], v[124:125], v[32:47]
  ds_read_b128 v[128:131], v127 offset:8064
  ds_read_b64 v[118:119], v1 offset:9088
  v_exp_f32 v24, v24
  v_exp_f32 v25, v25
  v_exp_f32 v26, v26
  v_exp_f32 v27, v27
  s_waitcnt lgkmcnt(3)
  v_smfmac_f32_32x32x32_bf16 v[48:63], v[132:135], v[16:23], v126
  v_exp_f32 v28, v28
  v_exp_f32 v29, v29
  v_exp_f32 v30, v30
  v_exp_f32 v31, v31
  v_exp_f32 v32, v32
  v_exp_f32 v33, v33
  s_waitcnt lgkmcnt(2)
  v_smfmac_f32_32x32x32_bf16 v[48:63], v[136:139], v[24:31], v126
  v_exp_f32 v34, v34
  v_exp_f32 v35, v35
  v_exp_f32 v36, v36
  s_waitcnt lgkmcnt(0)
  v_mfma_f32_32x32x16_bf16 v[16:31], v[128:131], v[112:115], 0
  v_exp_f32 v37, v37
  v_exp_f32 v38, v38
  v_exp_f32 v39, v39
  v_mfma_f32_32x32x8_bf16 v[16:31], v[118:119], v[116:117], v[16:31]
  v_exp_f32 v40, v40
  v_exp_f32 v41, v41
  v_exp_f32 v42, v42
  v_exp_f32 v43, v43
  v_smfmac_f32_32x32x32_bf16 v[64:79], v[132:135], v[32:39], v126
  ds_read_b128 v[132:135], v2 offset:9344
  v_exp_f32 v44, v44
  v_exp_f32 v45, v45
  v_exp_f32 v46, v46
  v_exp_f32 v47, v47
  v_exp_f32 v16, v16
  v_exp_f32 v17, v17
  v_smfmac_f32_32x32x32_bf16 v[64:79], v[136:139], v[40:47], v126
  ds_read_b128 v[136:139], v2 offset:10048
  v_exp_f32 v18, v18
  v_exp_f32 v19, v19
  v_exp_f32 v20, v20
  v_mfma_f32_32x32x16_bf16 v[32:47], v[128:131], v[120:123], 0
  v_exp_f32 v21, v21
  v_exp_f32 v22, v22
  v_exp_f32 v23, v23
  v_mfma_f32_32x32x8_bf16 v[32:47], v[118:119], v[124:125], v[32:47]
  s_waitcnt lgkmcnt(0)
  s_barrier
  ds_read_b128 v[128:131], v127 offset:24576
  ds_read_b64 v[118:119], v1 offset:25600
  v_exp_f32 v24, v24
  v_exp_f32 v25, v25
  v_exp_f32 v26, v26
  v_exp_f32 v27, v27
  v_smfmac_f32_32x32x32_bf16 v[48:63], v[132:135], v[16:23], v126
  v_exp_f32 v28, v28
  v_exp_f32 v29, v29
  v_exp_f32 v30, v30
  v_exp_f32 v31, v31
  v_exp_f32 v32, v32
  v_exp_f32 v33, v33
  s_waitcnt lgkmcnt(2)
  v_smfmac_f32_32x32x32_bf16 v[48:63], v[136:139], v[24:31], v126
  v_exp_f32 v34, v34
  v_exp_f32 v35, v35
  v_exp_f32 v36, v36
  s_waitcnt lgkmcnt(0)
  v_mfma_f32_32x32x16_bf16 v[16:31], v[128:131], v[112:115], 0
  v_exp_f32 v37, v37
  v_exp_f32 v38, v38
  v_exp_f32 v39, v39
  v_mfma_f32_32x32x8_bf16 v[16:31], v[118:119], v[116:117], v[16:31]
  v_exp_f32 v40, v40
  v_exp_f32 v41, v41
  v_exp_f32 v42, v42
  v_exp_f32 v43, v43
  v_smfmac_f32_32x32x32_bf16 v[64:79], v[132:135], v[32:39], v126
  ds_read_b128 v[132:135], v2 offset:25856
  v_exp_f32 v44, v44
  v_exp_f32 v45, v45
  v_exp_f32 v46, v46
  v_exp_f32 v47, v47
  v_exp_f32 v16, v16
  v_exp_f32 v17, v17
  v_smfmac_f32_32x32x32_bf16 v[64:79], v[136:139], v[40:47], v126
  ds_read_b128 v[136:139], v2 offset:26560
  v_exp_f32 v18, v18
  v_exp_f32 v19, v19
  v_exp_f32 v20, v20
  v_mfma_f32_32x32x16_bf16 v[32:47], v[128:131], v[120:123], 0
  v_exp_f32 v21, v21
  v_exp_f32 v22, v22
  v_exp_f32 v23, v23
  v_mfma_f32_32x32x8_bf16 v[32:47], v[118:119], v[124:125], v[32:47]
  ds_read_b128 v[128:131], v127 offset:27264
  ds_read_b64 v[118:119], v1 offset:28288
  v_exp_f32 v24, v24
  v_exp_f32 v25, v25
  v_exp_f32 v26, v26
  v_exp_f32 v27, v27
  s_waitcnt lgkmcnt(3)
  v_smfmac_f32_32x32x32_bf16 v[48:63], v[132:135], v[16:23], v126
  v_exp_f32 v28, v28
  v_exp_f32 v29, v29
  v_exp_f32 v30, v30
  v_exp_f32 v31, v31
  v_exp_f32 v32, v32
  v_exp_f32 v33, v33
  s_waitcnt lgkmcnt(2)
  v_smfmac_f32_32x32x32_bf16 v[48:63], v[136:139], v[24:31], v126
  v_exp_f32 v34, v34
  v_exp_f32 v35, v35
  v_exp_f32 v36, v36
  s_waitcnt lgkmcnt(0)
  v_mfma_f32_32x32x16_bf16 v[16:31], v[128:131], v[112:115], 0
  v_exp_f32 v37, v37
  v_exp_f32 v38, v38
  v_exp_f32 v39, v39
  v_mfma_f32_32x32x8_bf16 v[16:31], v[118:119], v[116:117], v[16:31]
  v_exp_f32 v40, v40
  v_exp_f32 v41, v41
  v_exp_f32 v42, v42
  v_exp_f32 v43, v43
  v_smfmac_f32_32x32x32_bf16 v[64:79], v[132:135], v[32:39], v126
  ds_read_b128 v[132:135], v2 offset:28544
  v_exp_f32 v44, v44
  v_exp_f32 v45, v45
  v_exp_f32 v46, v46
  v_exp_f32 v47, v47
  v_exp_f32 v16, v16
  v_exp_f32 v17, v17
  v_smfmac_f32_32x32x32_bf16 v[64:79], v[136:139], v[40:47], v126
  ds_read_b128 v[136:139], v2 offset:29248
  v_exp_f32 v18, v18
  v_exp_f32 v19, v19
  v_exp_f32 v20, v20
  v_mfma_f32_32x32x16_bf16 v[32:47], v[128:131], v[120:123], 0
  v_exp_f32 v21, v21
  v_exp_f32 v22, v22
  v_exp_f32 v23, v23
  v_mfma_f32_32x32x8_bf16 v[32:47], v[118:119], v[124:125], v[32:47]
  ds_read_b128 v[128:131], v127 offset:29952
  ds_read_b64 v[118:119], v1 offset:30976
  v_exp_f32 v24, v24
  v_exp_f32 v25, v25
  v_exp_f32 v26, v26
  v_exp_f32 v27, v27
  s_waitcnt lgkmcnt(3)
  v_smfmac_f32_32x32x32_bf16 v[48:63], v[132:135], v[16:23], v126
  v_exp_f32 v28, v28
  v_exp_f32 v29, v29
  v_exp_f32 v30, v30
  v_exp_f32 v31, v31
  v_exp_f32 v32, v32
  v_exp_f32 v33, v33
  s_waitcnt lgkmcnt(2)
  v_smfmac_f32_32x32x32_bf16 v[48:63], v[136:139], v[24:31], v126
  v_exp_f32 v34, v34
  v_exp_f32 v35, v35
  v_exp_f32 v36, v36
  s_waitcnt lgkmcnt(0)
  v_mfma_f32_32x32x16_bf16 v[16:31], v[128:131], v[112:115], 0
  v_exp_f32 v37, v37
  v_exp_f32 v38, v38
  v_exp_f32 v39, v39
  v_mfma_f32_32x32x8_bf16 v[16:31], v[118:119], v[116:117], v[16:31]
  v_exp_f32 v40, v40
  v_exp_f32 v41, v41
  v_exp_f32 v42, v42
  v_exp_f32 v43, v43
  v_smfmac_f32_32x32x32_bf16 v[64:79], v[132:135], v[32:39], v126
  ds_read_b128 v[132:135], v2 offset:31232
  v_exp_f32 v44, v44
  v_exp_f32 v45, v45
  v_exp_f32 v46, v46
  v_exp_f32 v47, v47
  v_exp_f32 v16, v16
  v_exp_f32 v17, v17
  v_smfmac_f32_32x32x32_bf16 v[64:79], v[136:139], v[40:47], v126
  ds_read_b128 v[136:139], v2 offset:31936
  v_exp_f32 v18, v18
  v_exp_f32 v19, v19
  v_exp_f32 v20, v20
  v_mfma_f32_32x32x16_bf16 v[32:47], v[128:131], v[120:123], 0
  v_exp_f32 v21, v21
  v_exp_f32 v22, v22
  v_exp_f32 v23, v23
  v_mfma_f32_32x32x8_bf16 v[32:47], v[118:119], v[124:125], v[32:47]
  ds_read_b128 v[128:131], v127 offset:32640
  ds_read_b64 v[118:119], v1 offset:33664
  v_exp_f32 v24, v24
  v_exp_f32 v25, v25
  v_exp_f32 v26, v26
  v_exp_f32 v27, v27
  s_waitcnt lgkmcnt(3)
  v_smfmac_f32_32x32x32_bf16 v[48:63], v[132:135], v[16:23], v126
  v_exp_f32 v28, v28
  v_exp_f32 v29, v29
  v_exp_f32 v30, v30
  v_exp_f32 v31, v31
  v_exp_f32 v32, v32
  v_exp_f32 v33, v33
  s_waitcnt lgkmcnt(2)
  v_smfmac_f32_32x32x32_bf16 v[48:63], v[136:139], v[24:31], v126
  v_exp_f32 v34, v34
  v_exp_f32 v35, v35
  v_exp_f32 v36, v36
  s_waitcnt lgkmcnt(0)
  v_mfma_f32_32x32x16_bf16 v[16:31], v[128:131], v[112:115], 0
  v_exp_f32 v37, v37
  v_exp_f32 v38, v38
  v_exp_f32 v39, v39
  v_mfma_f32_32x32x8_bf16 v[16:31], v[118:119], v[116:117], v[16:31]
  v_exp_f32 v40, v40
  v_exp_f32 v41, v41
  v_exp_f32 v42, v42
  v_exp_f32 v43, v43
  v_smfmac_f32_32x32x32_bf16 v[64:79], v[132:135], v[32:39], v126
  ds_read_b128 v[132:135], v2 offset:33920
  v_exp_f32 v44, v44
  v_exp_f32 v45, v45
  v_exp_f32 v46, v46
  v_exp_f32 v47, v47
  v_exp_f32 v16, v16
  v_exp_f32 v17, v17
  v_smfmac_f32_32x32x32_bf16 v[64:79], v[136:139], v[40:47], v126
  ds_read_b128 v[136:139], v2 offset:34624
  v_exp_f32 v18, v18
  v_exp_f32 v19, v19
  v_exp_f32 v20, v20
  v_mfma_f32_32x32x16_bf16 v[32:47], v[128:131], v[120:123], 0
  v_exp_f32 v21, v21
  v_exp_f32 v22, v22
  v_exp_f32 v23, v23
  v_mfma_f32_32x32x8_bf16 v[32:47], v[118:119], v[124:125], v[32:47]
  s_waitcnt lgkmcnt(0)
  s_barrier
  ds_read_b128 v[128:131], v127 offset:0
  ds_read_b64 v[118:119], v1 offset:1024
  v_exp_f32 v24, v24
  v_exp_f32 v25, v25
  v_exp_f32 v26, v26
  v_exp_f32 v27, v27
  v_smfmac_f32_32x32x32_bf16 v[48:63], v[132:135], v[16:23], v126
  v_exp_f32 v28, v28
  v_exp_f32 v29, v29
  v_exp_f32 v30, v30
  v_exp_f32 v31, v31
  v_exp_f32 v32, v32
  v_exp_f32 v33, v33
  s_waitcnt lgkmcnt(2)
  v_smfmac_f32_32x32x32_bf16 v[48:63], v[136:139], v[24:31], v126
  v_exp_f32 v34, v34
  v_exp_f32 v35, v35
  v_exp_f32 v36, v36
  s_waitcnt lgkmcnt(0)
  v_mfma_f32_32x32x16_bf16 v[16:31], v[128:131], v[112:115], 0
  v_exp_f32 v37, v37
  v_exp_f32 v38, v38
  v_exp_f32 v39, v39
  v_mfma_f32_32x32x8_bf16 v[16:31], v[118:119], v[116:117], v[16:31]
  v_exp_f32 v40, v40
  v_exp_f32 v41, v41
  v_exp_f32 v42, v42
  v_exp_f32 v43, v43
  v_smfmac_f32_32x32x32_bf16 v[64:79], v[132:135], v[32:39], v126
  ds_read_b128 v[132:135], v2 offset:1280
  v_exp_f32 v44, v44
  v_exp_f32 v45, v45
  v_exp_f32 v46, v46
  v_exp_f32 v47, v47
  s_add_u32 s20, s20, 1
  s_cmp_lt_u32 s20, 4
  s_cbranch_scc1 L_k2_kernel_loop
  ds_write_b128 v143, v[48:51] offset:49216
  v_smfmac_f32_32x32x32_bf16 v[64:79], v[136:139], v[40:47], v126
  ds_write_b128 v143, v[52:55] offset:50240
  v_lshlrev_b32 v7, 2, v4
  v_sub_u32 v8, v7, v3
  ds_write_b128 v143, v[56:59] offset:51264
  v_add_u32 v7, v143, v8
  v_add_u32 v8, v144, v8
  ds_write_b32 v7, v80 offset:52288
  v_mov_b32 v9, 0
  s_waitcnt lgkmcnt(0)
  s_barrier
  ds_read_b128 v[24:27], v144 offset:51264
  ds_read_b32 v28, v8 offset:52288
  ds_read_b128 v[16:19], v144 offset:49216
  ds_read_b128 v[20:23], v144 offset:50240
  ds_read_b32 v10, v9 offset:49184
  v_mov_b32 v76, v72
  v_mov_b32 v77, v72
  s_waitcnt lgkmcnt(3)
  v_mov_b32 v29, v24
  v_mov_b32 v30, v24
  v_permlane32_swap_b32 v77, v76
  s_nop 0
  v_permlane32_swap_b32 v30, v29
  v_log_f32 v5, v76
  v_log_f32 v6, v29
  v_max_f32 v9, v76, v29
  v_sub_f32 v5, v5, v96
  v_sub_f32 v6, v6, v28
  v_max_f32 v5, v5, v6
  v_add_f32 v6, v5, v28
  v_add_f32 v5, v5, v96
  v_exp_f32_e64 v5, -v5
  v_exp_f32_e64 v6, -v6
  v_cmp_ngt_f32 vcc, 0x7b800000, v9
  v_mul_f32 v7, v5, v76
  v_fmac_f32 v7, v6, v29
  v_rcp_f32 v7, v7
  s_mov_b64 s[24:25], vcc
  v_mul_f32 v5, v5, v7
  v_mul_f32 v6, v6, v7
  s_waitcnt lgkmcnt(0)
  v_readfirstlane_b32 s29, v10
  v_mul_f32 v64, v5, v64
  v_fmac_f32 v64, v6, v16
  v_mul_f32 v65, v5, v65
  v_fmac_f32 v65, v6, v17
  v_mul_f32 v66, v5, v66
  v_fmac_f32 v66, v6, v18
  v_mul_f32 v67, v5, v67
  v_fmac_f32 v67, v6, v19
  v_mul_f32 v68, v5, v68
  v_fmac_f32 v68, v6, v20
  v_mul_f32 v69, v5, v69
  v_fmac_f32 v69, v6, v21
  v_mul_f32 v70, v5, v70
  v_fmac_f32 v70, v6, v22
  v_mul_f32 v71, v5, v71
  v_fmac_f32 v71, v6, v23
  v_mul_f32 v72, v5, v72
  v_fmac_f32 v72, v6, v24
  v_mul_f32 v73, v5, v73
  v_fmac_f32 v73, v6, v25
  v_mul_f32 v74, v5, v74
  v_fmac_f32 v74, v6, v26
  v_mul_f32 v75, v5, v75
  v_fmac_f32 v75, v6, v27
  v_add_f32_e64 v7, |v64|, |v65|
  v_add_f32_e64 v8, |v72|, |v73|
  v_add_f32_e64 v7, v7, |v66|
  v_add_f32_e64 v7, v7, |v67|
  v_add_f32_e64 v7, v7, |v68|
  v_add_f32_e64 v7, v7, |v69|
  v_add_f32_e64 v7, v7, |v70|
  v_add_f32_e64 v7, v7, |v71|
  v_add_f32_e64 v8, v8, |v74|
  v_add_f32_e64 v8, v8, |v75|
  v_max_f32 v5, v5, v6
  v_add_f32 v8, v8, v7
  v_mul_f32 v5, 0x0d800000, v5
  v_cmp_ngt_f32 vcc, 0x7f800000, v8
  s_or_b64 s[24:25], s[24:25], vcc
  v_cmp_gt_f32 vcc, v5, v7
  s_or_b64 s[24:25], s[24:25], vcc
  v_cvt_pk_bf16_f32 v16, v64, v65
  v_cvt_pk_bf16_f32 v17, v66, v67
  v_cvt_pk_bf16_f32 v18, v68, v69
  v_cvt_pk_bf16_f32 v19, v70, v71
  v_cvt_pk_bf16_f32 v20, v72, v73
  v_cvt_pk_bf16_f32 v21, v74, v75
  ds_write_b64 v140, v[16:17] offset:24576
  ds_write_b64 v141, v[18:19] offset:24576
  s_mov_b32 exec_hi, 0
  ds_write_b64 v142, v[20:21] offset:24576
  s_mov_b32 exec_hi, -1
  s_cmp_lg_u64 s[24:25], 0
  s_cselect_b32 s3, 1, 0
  s_andn2_b32 s3, s3, s19
  v_mov_b32 v10, s3
  s_lshl_b32 s3, s12, 2
  v_mov_b32 v9, s3
  ds_write_b32 v9, v10 offset:49152
  v_mov_b32 v9, 0
  s_waitcnt lgkmcnt(0)
  s_barrier
  ds_read_b128 v[32:35], v9 offset:49152
  ds_read_b128 v[36:39], v9 offset:49168
  ds_read_b128 v[48:51], v145 offset:24576
  ds_read_b128 v[52:55], v145 offset:32768
  s_waitcnt lgkmcnt(2)
  v_or3_b32 v32, v32, v33, v34
  v_or3_b32 v32, v32, v35, v36
  v_or3_b32 v32, v32, v37, v38
  v_or_b32 v32, v32, v39
  s_nop 1
  v_readfirstlane_b32 s3, v32
  s_nop 1
  s_cmp_lg_u32 s3, 0
  s_cbranch_scc1 L_k2_kernel_exact
  s_cmp_eq_u32 s29, 1
  s_waitcnt lgkmcnt(0)
  s_cbranch_scc0 L_k2_kernel_slowpub
  buffer_store_dwordx4 v[48:51], v3, s[8:11], s27 offen
  buffer_store_dwordx4 v[52:55], v3, s[8:11], s28 offen
  s_branch L_k2_kernel_fin
L_k2_kernel_slowpub:
  buffer_store_dwordx4 v[48:51], v3, s[8:11], s27 offen sc0 sc1
  buffer_store_dwordx4 v[52:55], v3, s[8:11], s28 offen sc0 sc1
  s_branch L_k2_kernel_fin
L_k2_kernel_exact:
  s_mov_b32 s19, 1
  s_mov_b32 s20, 0
  s_mov_b64 exec, s[22:23]
  v_mov_b32 v116, 0
  v_mov_b32 v117, 0
  v_mov_b32 v124, 0
  v_mov_b32 v125, 0
  s_mov_b64 exec, -1
  v_mov_b32 v5, 0xff800000
  v_mov_b32 v6, 0xff800000
L_k2_kernel_exloop:
  s_waitcnt lgkmcnt(0)
  s_barrier
  s_barrier
  ds_read_b128 v[128:131], v127 offset:0
  ds_read_b64 v[118:119], v1 offset:1024
  s_waitcnt lgkmcnt(0)
  v_mfma_f32_32x32x16_bf16 v[16:31], v[128:131], v[112:115], 0
  v_mfma_f32_32x32x8_bf16 v[16:31], v[118:119], v[116:117], v[16:31]
  v_mfma_f32_32x32x16_bf16 v[32:47], v[128:131], v[120:123], 0
  v_mfma_f32_32x32x8_bf16 v[32:47], v[118:119], v[124:125], v[32:47]
  s_nop 15
  v_max3_f32 v5, v5, v16, v17
  v_max3_f32 v5, v5, v18, v19
  v_max3_f32 v5, v5, v20, v21
  v_max3_f32 v5, v5, v22, v23
  v_max3_f32 v5, v5, v24, v25
  v_max3_f32 v5, v5, v26, v27
  v_max3_f32 v5, v5, v28, v29
  v_max3_f32 v5, v5, v30, v31
  v_max3_f32 v6, v6, v32, v33
  v_max3_f32 v6, v6, v34, v35
  v_max3_f32 v6, v6, v36, v37
  v_max3_f32 v6, v6, v38, v39
  v_max3_f32 v6, v6, v40, v41
  v_max3_f32 v6, v6, v42, v43
  v_max3_f32 v6, v6, v44, v45
  v_max3_f32 v6, v6, v46, v47
  ds_read_b128 v[128:131], v127 offset:2688
  ds_read_b64 v[118:119], v1 offset:3712
  s_waitcnt lgkmcnt(0)
  v_mfma_f32_32x32x16_bf16 v[16:31], v[128:131], v[112:115], 0
  v_mfma_f32_32x32x8_bf16 v[16:31], v[118:119], v[116:117], v[16:31]
  v_mfma_f32_32x32x16_bf16 v[32:47], v[128:131], v[120:123], 0
  v_mfma_f32_32x32x8_bf16 v[32:47], v[118:119], v[124:125], v[32:47]
  s_nop 15
  v_max3_f32 v5, v5, v16, v17
  v_max3_f32 v5, v5, v18, v19
  v_max3_f32 v5, v5, v20, v21
  v_max3_f32 v5, v5, v22, v23
  v_max3_f32 v5, v5, v24, v25
  v_max3_f32 v5, v5, v26, v27
  v_max3_f32 v5, v5, v28, v29
  v_max3_f32 v5, v5, v30, v31
  v_max3_f32 v6, v6, v32, v33
  v_max3_f32 v6, v6, v34, v35
  v_max3_f32 v6, v6, v36, v37
  v_max3_f32 v6, v6, v38, v39
  v_max3_f32 v6, v6, v40, v41
  v_max3_f32 v6, v6, v42, v43
  v_max3_f32 v6, v6, v44, v45
  v_max3_f32 v6, v6, v46, v47
  ds_read_b128 v[128:131], v127 offset:5376
  ds_read_b64 v[118:119], v1 offset:6400
  s_waitcnt lgkmcnt(0)
  v_mfma_f32_32x32x16_bf16 v[16:31], v[128:131], v[112:115], 0
  v_mfma_f32_32x32x8_bf16 v[16:31], v[118:119], v[116:117], v[16:31]
  v_mfma_f32_32x32x16_bf16 v[32:47], v[128:131], v[120:123], 0
  v_mfma_f32_32x32x8_bf16 v[32:47], v[118:119], v[124:125], v[32:47]
  s_nop 15
  v_max3_f32 v5, v5, v16, v17
  v_max3_f32 v5, v5, v18, v19
  v_max3_f32 v5, v5, v20, v21
  v_max3_f32 v5, v5, v22, v23
  v_max3_f32 v5, v5, v24, v25
  v_max3_f32 v5, v5, v26, v27
  v_max3_f32 v5, v5, v28, v29
  v_max3_f32 v5, v5, v30, v31
  v_max3_f32 v6, v6, v32, v33
  v_max3_f32 v6, v6, v34, v35
  v_max3_f32 v6, v6, v36, v37
  v_max3_f32 v6, v6, v38, v39
  v_max3_f32 v6, v6, v40, v41
  v_max3_f32 v6, v6, v42, v43
  v_max3_f32 v6, v6, v44, v45
  v_max3_f32 v6, v6, v46, v47
  ds_read_b128 v[128:131], v127 offset:8064
  ds_read_b64 v[118:119], v1 offset:9088
  s_waitcnt lgkmcnt(0)
  v_mfma_f32_32x32x16_bf16 v[16:31], v[128:131], v[112:115], 0
  v_mfma_f32_32x32x8_bf16 v[16:31], v[118:119], v[116:117], v[16:31]
  v_mfma_f32_32x32x16_bf16 v[32:47], v[128:131], v[120:123], 0
  v_mfma_f32_32x32x8_bf16 v[32:47], v[118:119], v[124:125], v[32:47]
  s_nop 15
  v_max3_f32 v5, v5, v16, v17
  v_max3_f32 v5, v5, v18, v19
  v_max3_f32 v5, v5, v20, v21
  v_max3_f32 v5, v5, v22, v23
  v_max3_f32 v5, v5, v24, v25
  v_max3_f32 v5, v5, v26, v27
  v_max3_f32 v5, v5, v28, v29
  v_max3_f32 v5, v5, v30, v31
  v_max3_f32 v6, v6, v32, v33
  v_max3_f32 v6, v6, v34, v35
  v_max3_f32 v6, v6, v36, v37
  v_max3_f32 v6, v6, v38, v39
  v_max3_f32 v6, v6, v40, v41
  v_max3_f32 v6, v6, v42, v43
  v_max3_f32 v6, v6, v44, v45
  v_max3_f32 v6, v6, v46, v47
  s_add_u32 s20, s20, 1
  s_cmp_lt_u32 s20, 8
  s_cbranch_scc1 L_k2_kernel_exloop
  v_mov_b32 v7, v5
  s_nop 1
  v_permlane32_swap_b32 v5, v7
  s_nop 1
  v_max_f32 v5, v5, v7
  v_sub_f32 v80, 0x80000000, v5
  v_and_b32 v7, 0xffff0000, v80
  v_sub_f32 v8, v80, v7
  v_and_b32 v9, 0xffff0000, v8
  v_sub_f32 v8, v8, v9
  v_lshrrev_b32 v7, 16, v7
  v_or_b32 v7, v7, v9
  v_lshrrev_b32 v8, 16, v8
  v_cndmask_b32 v116, v116, v7, s[22:23]
  v_cndmask_b32 v117, v117, v8, s[22:23]
  v_mov_b32 v7, v6
  s_nop 1
  v_permlane32_swap_b32 v6, v7
  s_nop 1
  v_max_f32 v6, v6, v7
  v_sub_f32 v96, 0x80000000, v6
  v_and_b32 v7, 0xffff0000, v96
  v_sub_f32 v8, v96, v7
  v_and_b32 v9, 0xffff0000, v8
  v_sub_f32 v8, v8, v9
  v_lshrrev_b32 v7, 16, v7
  v_or_b32 v7, v7, v9
  v_lshrrev_b32 v8, 16, v8
  v_cndmask_b32 v124, v124, v7, s[22:23]
  v_cndmask_b32 v125, v125, v8, s[22:23]
  s_barrier
  s_branch L_k2_kernel_start
L_k2_kernel_gemm:
  s_setprio 3
  s_sub_u32 s13, s12, 8
  s_mul_i32 s18, s13, 6144
  s_add_u32 s17, s18, 2621440
  s_waitcnt lgkmcnt(0)
  s_mov_b32 s8, s4
  s_mov_b32 s9, s5
  s_mov_b32 s10, 0x1000000
  s_mov_b32 s11, 0x00020000
  s_add_u32 m0, s18, 0
  s_add_u32 s3, s17, 4096
  buffer_load_dwordx4 v3, s[8:11], s17 offen offset:0 lds
  buffer_load_dwordx4 v3, s[8:11], s17 offen offset:1024 lds
  buffer_load_dwordx4 v3, s[8:11], s17 offen offset:2048 lds
  buffer_load_dwordx4 v3, s[8:11], s17 offen offset:3072 lds
  s_add_u32 m0, s18, 4096
  s_add_u32 s17, s17, 21504
  buffer_load_dwordx4 v3, s[8:11], s3 offen offset:0 lds
  buffer_load_dwordx4 v3, s[8:11], s3 offen offset:1024 lds
  s_and_b32 s14, s26, 1
  s_lshr_b32 s3, s26, 1
  s_mul_i32 s3, s3, 5
  s_add_u32 s27, s3, 2
  s_mul_i32 s6, s14, 3
  s_add_u32 s15, s3, s6
  s_add_u32 s16, s15, 1
  s_mul_i32 s7, s13, 27648
  s_lshl_b32 s3, s21, 1
  s_add_u32 s6, s3, s14
  s_mul_i32 s28, s6, 151552
  s_mul_i32 s34, s6, 40960
  s_xor_b32 s6, s6, 1
  s_mul_i32 s29, s6, 151552
  s_mul_i32 s35, s6, 40960
  s_mul_i32 s30, s15, 151552
  s_mul_i32 s31, s16, 151552
  s_mul_i32 s32, s27, 151552
  s_add_u32 s3, s7, 2883584
  s_add_u32 s28, s28, s3
  s_add_u32 s29, s29, s3
  s_add_u32 s3, s7, 12582912
  s_add_u32 s30, s30, s3
  s_add_u32 s31, s31, s3
  s_add_u32 s32, s32, s3
  s_mul_i32 s33, s13, 17408
  s_sub_u32 s3, 110592, s33
  s_add_u32 s57, s30, s3
  s_add_u32 s58, s31, s3
  s_add_u32 s59, s32, s3
  s_mul_i32 s61, s13, 21504
  s_add_u32 s61, s61, 76800
  s_lshl_b32 s3, s13, 3
  v_add_u32 v5, s3, v4
  v_and_b32 v5, 31, v5
  v_and_b32 v1, 32, v4
  v_or_b32 v5, v5, v1
  v_lshlrev_b32 v5, 4, v5
  s_lshl_b32 s15, s15, 6
  s_lshl_b32 s16, s16, 6
  s_lshl_b32 s27, s27, 6
  s_lshl_b32 s3, s13, 4
  v_lshrrev_b32 v2, 2, v1
  v_add_u32 v2, s3, v2
  v_mov_b32 v0, v2
  s_cmp_lt_u32 s13, 2
  s_cselect_b32 s56, s34, s35
  s_and_b32 s3, s13, 1
  s_mul_i32 s3, s3, 20480
  s_add_u32 s56, s56, s3
  s_min_u32 s3, s15, s27
  s_add_u32 s56, s56, s3
  s_getreg_b32 s38, hwreg(HW_REG_XCC_ID)
  s_and_b32 s38, s38, 15
  s_add_u32 s38, s38, 1
  s_mov_b32 s44, s36
  s_mov_b32 s45, s37
  s_mov_b32 s46, 0x280000
  s_mov_b32 s47, 0x00020000
  s_mov_b32 s48, s40
  s_mov_b32 s49, s41
  s_mov_b32 s50, 0x500
  s_mov_b32 s51, 0x00020000
  s_mov_b32 s52, s42
  s_mov_b32 s53, s43
  s_mov_b32 s54, 0x280000
  s_mov_b32 s55, 0x00020000
  buffer_load_dwordx2 v[96:97], v0, s[48:51], s15 offen
  buffer_load_dwordx2 v[98:99], v0, s[48:51], s16 offen
  buffer_load_dwordx2 v[100:101], v0, s[48:51], s27 offen
  v_mov_b32 v12, 0
  v_mov_b32 v13, 0
  v_mov_b32 v14, 0
  v_mov_b32 v15, 0
  v_mov_b32 v16, 0
  v_mov_b32 v17, 0
  v_mov_b32 v18, 0
  v_mov_b32 v19, 0
  v_mov_b32 v20, 0
  v_mov_b32 v21, 0
  v_mov_b32 v22, 0
  v_mov_b32 v23, 0
  v_mov_b32 v28, 0
  v_mov_b32 v29, 0
  v_mov_b32 v30, 0
  v_mov_b32 v31, 0
  v_mov_b32 v32, 0
  v_mov_b32 v33, 0
  v_mov_b32 v34, 0
  v_mov_b32 v35, 0
  v_mov_b32 v36, 0
  v_mov_b32 v37, 0
  v_mov_b32 v38, 0
  v_mov_b32 v39, 0
  v_mov_b32 v44, 0
  v_mov_b32 v45, 0
  v_mov_b32 v46, 0
  v_mov_b32 v47, 0
  v_mov_b32 v48, 0
  v_mov_b32 v49, 0
  v_mov_b32 v50, 0
  v_mov_b32 v51, 0
  v_mov_b32 v52, 0
  v_mov_b32 v53, 0
  v_mov_b32 v54, 0
  v_mov_b32 v55, 0
  v_mov_b32 v60, 0
  v_mov_b32 v61, 0
  v_mov_b32 v62, 0
  v_mov_b32 v63, 0
  v_mov_b32 v64, 0
  v_mov_b32 v65, 0
  v_mov_b32 v66, 0
  v_mov_b32 v67, 0
  v_mov_b32 v68, 0
  v_mov_b32 v69, 0
  v_mov_b32 v70, 0
  v_mov_b32 v71, 0
  v_mov_b32 v76, 0
  v_mov_b32 v77, 0
  v_mov_b32 v78, 0
  v_mov_b32 v79, 0
  v_mov_b32 v80, 0
  v_mov_b32 v81, 0
  v_mov_b32 v82, 0
  v_mov_b32 v83, 0
  v_mov_b32 v84, 0
  v_mov_b32 v85, 0
  v_mov_b32 v86, 0
  v_mov_b32 v87, 0
  s_lshl_b32 s6, s14, 6
  s_lshl_b32 s7, s14, 7
  s_sub_u32 s7, 0, s7
  s_cmp_lt_u32 s13, 2
  s_cselect_b32 s7, s7, 0x40000000
  v_add_u32 v89, 0, v4
  v_mul_u32_u24 v90, 43691, v89
  v_lshrrev_b32 v90, 19, v90
  v_mul_u32_u24 v1, 12, v90
  v_sub_u32 v89, v89, v1
  v_lshrrev_b32 v1, 2, v90
  v_xor_b32 v89, v89, v1
  v_cmp_gt_u32 vcc, 8, v89
  v_mul_u32_u24 v90, 1280, v90
  v_lshl_add_u32 v90, v89, 4, v90
  v_add_u32 v89, s6, v90
  v_add_u32 v90, s7, v90
  v_cndmask_b32 v0, v90, v89, vcc
  v_add_u32 v89, 64, v4
  v_mul_u32_u24 v90, 43691, v89
  v_lshrrev_b32 v90, 19, v90
  v_mul_u32_u24 v1, 12, v90
  v_sub_u32 v89, v89, v1
  v_lshrrev_b32 v1, 2, v90
  v_xor_b32 v89, v89, v1
  v_cmp_gt_u32 vcc, 8, v89
  v_mul_u32_u24 v90, 1280, v90
  v_lshl_add_u32 v90, v89, 4, v90
  v_add_u32 v89, s6, v90
  v_add_u32 v90, s7, v90
  v_cndmask_b32 v6, v90, v89, vcc
  v_add_u32 v89, 128, v4
  v_mul_u32_u24 v90, 43691, v89
  v_lshrrev_b32 v90, 19, v90
  v_mul_u32_u24 v1, 12, v90
  v_sub_u32 v89, v89, v1
  v_lshrrev_b32 v1, 2, v90
  v_xor_b32 v89, v89, v1
  v_cmp_gt_u32 vcc, 8, v89
  v_mul_u32_u24 v90, 1280, v90
  v_lshl_add_u32 v90, v89, 4, v90
  v_add_u32 v89, s6, v90
  v_add_u32 v90, s7, v90
  v_cndmask_b32 v2, v90, v89, vcc
  s_waitcnt vmcnt(3)
  s_barrier
  s_add_u32 m0, s18, 24576
  s_add_u32 s3, s17, 4096
  buffer_load_dwordx4 v3, s[8:11], s17 offen offset:0 lds
  buffer_load_dwordx4 v3, s[8:11], s17 offen offset:1024 lds
  buffer_load_dwordx4 v3, s[8:11], s17 offen offset:2048 lds
  buffer_load_dwordx4 v3, s[8:11], s17 offen offset:3072 lds
  s_add_u32 m0, s18, 28672
  s_add_u32 s17, s17, 21504
  buffer_load_dwordx4 v3, s[8:11], s3 offen offset:0 lds
  buffer_load_dwordx4 v3, s[8:11], s3 offen offset:1024 lds
  s_waitcnt vmcnt(6)
  v_lshlrev_b32 v8, 16, v96
  v_lshlrev_b32 v24, 16, v96
  v_and_b32 v9, 0xffff0000, v96
  v_and_b32 v25, 0xffff0000, v96
  v_lshlrev_b32 v10, 16, v97
  v_lshlrev_b32 v26, 16, v97
  v_and_b32 v11, 0xffff0000, v97
  v_and_b32 v27, 0xffff0000, v97
  v_lshlrev_b32 v40, 16, v98
  v_lshlrev_b32 v56, 16, v98
  v_and_b32 v41, 0xffff0000, v98
  v_and_b32 v57, 0xffff0000, v98
  v_lshlrev_b32 v42, 16, v99
  v_lshlrev_b32 v58, 16, v99
  v_and_b32 v43, 0xffff0000, v99
  v_and_b32 v59, 0xffff0000, v99
  v_lshlrev_b32 v72, 16, v100
  v_and_b32 v73, 0xffff0000, v100
  v_lshlrev_b32 v74, 16, v101
  v_and_b32 v75, 0xffff0000, v101
  buffer_load_dwordx4 v[88:91], v3, s[8:11], s28 offen offset:0
  buffer_load_dwordx4 v[92:95], v3, s[8:11], s29 offen offset:0
  buffer_load_dwordx4 v[96:99], v5, s[8:11], s30 offen offset:0
  buffer_load_dwordx4 v[100:103], v5, s[8:11], s31 offen offset:0
  buffer_load_dwordx4 v[104:107], v5, s[8:11], s32 offen offset:0
  buffer_load_dwordx4 v[108:111], v3, s[8:11], s28 offen offset:1024
  buffer_load_dwordx4 v[112:115], v3, s[8:11], s29 offen offset:1024
  buffer_load_dwordx4 v[116:119], v5, s[8:11], s30 offen offset:1024
  buffer_load_dwordx4 v[120:123], v5, s[8:11], s31 offen offset:1024
  buffer_load_dwordx4 v[124:127], v5, s[8:11], s32 offen offset:1024
  buffer_load_dwordx4 v[128:131], v3, s[8:11], s28 offen offset:2048
  buffer_load_dwordx4 v[132:135], v3, s[8:11], s29 offen offset:2048
  buffer_load_dwordx4 v[136:139], v5, s[8:11], s30 offen offset:2048
  buffer_load_dwordx4 v[140:143], v5, s[8:11], s31 offen offset:2048
  buffer_load_dwordx4 v[144:147], v5, s[8:11], s32 offen offset:2048
  s_lshl_b32 s3, s21, 1
  s_add_u32 s3, s3, s13
  s_mul_i32 s3, s3, 151552
  s_mul_i32 s6, s26, 5120
  s_add_u32 s3, s3, s6
  s_add_u32 s3, s3, 2994176
  s_cmp_lt_u32 s13, 2
  s_cselect_b32 s3, s3, 0x40000000
  s_add_u32 s6, s3, 4096
  v_mov_b32 v148, -1
  v_mov_b32 v149, -1
  v_mov_b32 v150, -1
  v_mov_b32 v151, -1
  buffer_store_dwordx4 v[148:151], v3, s[8:11], s3 offen offset:0 sc0 sc1
  buffer_store_dwordx4 v[148:151], v3, s[8:11], s3 offen offset:1024 sc0 sc1
  buffer_store_dwordx4 v[148:151], v3, s[8:11], s3 offen offset:2048 sc0 sc1
  buffer_store_dwordx4 v[148:151], v3, s[8:11], s3 offen offset:3072 sc0 sc1
  buffer_store_dwordx4 v[148:151], v3, s[8:11], s6 offen offset:0 sc0 sc1
  buffer_load_dwordx4 v[148:151], v3, s[8:11], s28 offen offset:3072
  buffer_load_dwordx4 v[152:155], v3, s[8:11], s29 offen offset:3072
  buffer_load_dwordx4 v[156:159], v5, s[8:11], s30 offen offset:3072
  buffer_load_dwordx4 v[160:163], v5, s[8:11], s31 offen offset:3072
  buffer_load_dwordx4 v[164:167], v5, s[8:11], s32 offen offset:3072
  s_add_u32 m0, s61, 0
  s_add_u32 s3, s57, 0
  buffer_load_dwordx4 v5, s[8:11], s3 offen offset:0 lds
  s_add_u32 m0, s61, 7168
  s_add_u32 s3, s58, 0
  buffer_load_dwordx4 v5, s[8:11], s3 offen offset:0 lds
  s_add_u32 m0, s61, 14336
  s_add_u32 s3, s59, 0
  buffer_load_dwordx4 v5, s[8:11], s3 offen offset:0 lds
  s_waitcnt vmcnt(23)
  s_setprio 0
  v_mfma_f32_32x32x16_bf16 v[8:23], v[96:99], v[88:91], v[8:23]
  v_mfma_f32_32x32x16_bf16 v[24:39], v[96:99], v[92:95], v[24:39]
  v_mfma_f32_32x32x16_bf16 v[40:55], v[100:103], v[88:91], v[40:55]
  v_mfma_f32_32x32x16_bf16 v[56:71], v[100:103], v[92:95], v[56:71]
  v_mfma_f32_32x32x16_bf16 v[72:87], v[104:107], v[88:91], v[72:87]
  s_setprio 3
  s_add_u32 s28, s28, 4096
  buffer_load_dwordx4 v[88:91], v3, s[8:11], s28 offen offset:0
  s_add_u32 s29, s29, 4096
  buffer_load_dwordx4 v[92:95], v3, s[8:11], s29 offen offset:0
  s_add_u32 s30, s30, 4096
  buffer_load_dwordx4 v[96:99], v5, s[8:11], s30 offen offset:0
  s_add_u32 s31, s31, 4096
  buffer_load_dwordx4 v[100:103], v5, s[8:11], s31 offen offset:0
  s_add_u32 s32, s32, 4096
  buffer_load_dwordx4 v[104:107], v5, s[8:11], s32 offen offset:0
  s_waitcnt vmcnt(23)
  s_setprio 0
  v_mfma_f32_32x32x16_bf16 v[8:23], v[116:119], v[108:111], v[8:23]
  v_mfma_f32_32x32x16_bf16 v[24:39], v[116:119], v[112:115], v[24:39]
  v_mfma_f32_32x32x16_bf16 v[40:55], v[120:123], v[108:111], v[40:55]
  v_mfma_f32_32x32x16_bf16 v[56:71], v[120:123], v[112:115], v[56:71]
  v_mfma_f32_32x32x16_bf16 v[72:87], v[124:127], v[108:111], v[72:87]
  s_setprio 3
  buffer_load_dwordx4 v[108:111], v3, s[8:11], s28 offen offset:1024
  buffer_load_dwordx4 v[112:115], v3, s[8:11], s29 offen offset:1024
  buffer_load_dwordx4 v[116:119], v5, s[8:11], s30 offen offset:1024
  buffer_load_dwordx4 v[120:123], v5, s[8:11], s31 offen offset:1024
  buffer_load_dwordx4 v[124:127], v5, s[8:11], s32 offen offset:1024
  s_barrier
  s_add_u32 m0, s18, 0
  s_add_u32 s3, s17, 4096
  buffer_load_dwordx4 v3, s[8:11], s17 offen offset:0 lds
  buffer_load_dwordx4 v3, s[8:11], s17 offen offset:1024 lds
  buffer_load_dwordx4 v3, s[8:11], s17 offen offset:2048 lds
  buffer_load_dwordx4 v3, s[8:11], s17 offen offset:3072 lds
  s_add_u32 m0, s18, 4096
  s_add_u32 s17, s17, 21504
  buffer_load_dwordx4 v3, s[8:11], s3 offen offset:0 lds
  buffer_load_dwordx4 v3, s[8:11], s3 offen offset:1024 lds
  s_add_u32 m0, s61, 1024
  s_add_u32 s3, s57, 1024
  buffer_load_dwordx4 v5, s[8:11], s3 offen offset:0 lds
  s_add_u32 m0, s61, 8192
  s_add_u32 s3, s58, 1024
  buffer_load_dwordx4 v5, s[8:11], s3 offen offset:0 lds
  s_add_u32 m0, s61, 15360
  s_add_u32 s3, s59, 1024
  buffer_load_dwordx4 v5, s[8:11], s3 offen offset:0 lds
  s_waitcnt vmcnt(32)
  s_setprio 0
  v_mfma_f32_32x32x16_bf16 v[8:23], v[136:139], v[128:131], v[8:23]
  v_mfma_f32_32x32x16_bf16 v[24:39], v[136:139], v[132:135], v[24:39]
  v_mfma_f32_32x32x16_bf16 v[40:55], v[140:143], v[128:131], v[40:55]
  v_mfma_f32_32x32x16_bf16 v[56:71], v[140:143], v[132:135], v[56:71]
  v_mfma_f32_32x32x16_bf16 v[72:87], v[144:147], v[128:131], v[72:87]
  s_setprio 3
  buffer_load_dwordx4 v[128:131], v3, s[8:11], s28 offen offset:2048
  buffer_load_dwordx4 v[132:135], v3, s[8:11], s29 offen offset:2048
  buffer_load_dwordx4 v[136:139], v5, s[8:11], s30 offen offset:2048
  buffer_load_dwordx4 v[140:143], v5, s[8:11], s31 offen offset:2048
  buffer_load_dwordx4 v[144:147], v5, s[8:11], s32 offen offset:2048
  s_waitcnt vmcnt(27)
  s_setprio 0
  v_mfma_f32_32x32x16_bf16 v[8:23], v[156:159], v[148:151], v[8:23]
  v_mfma_f32_32x32x16_bf16 v[24:39], v[156:159], v[152:155], v[24:39]
  v_mfma_f32_32x32x16_bf16 v[40:55], v[160:163], v[148:151], v[40:55]
  v_mfma_f32_32x32x16_bf16 v[56:71], v[160:163], v[152:155], v[56:71]
  v_mfma_f32_32x32x16_bf16 v[72:87], v[164:167], v[148:151], v[72:87]
  s_setprio 3
  buffer_load_dwordx4 v[148:151], v3, s[8:11], s28 offen offset:3072
  buffer_load_dwordx4 v[152:155], v3, s[8:11], s29 offen offset:3072
  buffer_load_dwordx4 v[156:159], v5, s[8:11], s30 offen offset:3072
  buffer_load_dwordx4 v[160:163], v5, s[8:11], s31 offen offset:3072
  buffer_load_dwordx4 v[164:167], v5, s[8:11], s32 offen offset:3072
  s_waitcnt vmcnt(24)
  s_setprio 0
  v_mfma_f32_32x32x16_bf16 v[8:23], v[96:99], v[88:91], v[8:23]
  v_mfma_f32_32x32x16_bf16 v[24:39], v[96:99], v[92:95], v[24:39]
  v_mfma_f32_32x32x16_bf16 v[40:55], v[100:103], v[88:91], v[40:55]
  v_mfma_f32_32x32x16_bf16 v[56:71], v[100:103], v[92:95], v[56:71]
  v_mfma_f32_32x32x16_bf16 v[72:87], v[104:107], v[88:91], v[72:87]
  s_setprio 3
  s_add_u32 s28, s28, 4096
  buffer_load_dwordx4 v[88:91], v3, s[8:11], s28 offen offset:0
  s_add_u32 s29, s29, 4096
  buffer_load_dwordx4 v[92:95], v3, s[8:11], s29 offen offset:0
  s_add_u32 s30, s30, 4096
  buffer_load_dwordx4 v[96:99], v5, s[8:11], s30 offen offset:0
  s_add_u32 s31, s31, 4096
  buffer_load_dwordx4 v[100:103], v5, s[8:11], s31 offen offset:0
  s_add_u32 s32, s32, 4096
  buffer_load_dwordx4 v[104:107], v5, s[8:11], s32 offen offset:0
  s_lshl_b32 s62, s21, 7
  s_add_u32 s62, s62, 15613952
  s_lshl_b32 s3, s26, 3
  s_lshl_b32 s6, s13, 2
  s_add_u32 s3, s3, s6
  s_cmp_lt_u32 s13, 2
  s_cselect_b32 s3, s3, 0x40000000
  v_mov_b32 v1, s3
  v_mov_b32 v7, s38
  s_mov_b64 exec, 1
  buffer_store_dword v7, v1, s[8:11], s62 offen sc0 sc1
  s_mov_b64 exec, -1
  s_waitcnt vmcnt(19)
  s_barrier
  s_add_u32 m0, s18, 24576
  s_add_u32 s3, s17, 4096
  buffer_load_dwordx4 v3, s[8:11], s17 offen offset:0 lds
  buffer_load_dwordx4 v3, s[8:11], s17 offen offset:1024 lds
  buffer_load_dwordx4 v3, s[8:11], s17 offen offset:2048 lds
  buffer_load_dwordx4 v3, s[8:11], s17 offen offset:3072 lds
  s_add_u32 m0, s18, 28672
  s_add_u32 s17, s17, 21504
  buffer_load_dwordx4 v3, s[8:11], s3 offen offset:0 lds
  buffer_load_dwordx4 v3, s[8:11], s3 offen offset:1024 lds
  s_add_u32 m0, s61, 2048
  s_add_u32 s3, s57, 2048
  buffer_load_dwordx4 v5, s[8:11], s3 offen offset:0 lds
  s_add_u32 m0, s61, 9216
  s_add_u32 s3, s58, 2048
  buffer_load_dwordx4 v5, s[8:11], s3 offen offset:0 lds
  s_add_u32 m0, s61, 16384
  s_add_u32 s3, s59, 2048
  buffer_load_dwordx4 v5, s[8:11], s3 offen offset:0 lds
  s_setprio 0
  v_mfma_f32_32x32x16_bf16 v[8:23], v[116:119], v[108:111], v[8:23]
  v_mfma_f32_32x32x16_bf16 v[24:39], v[116:119], v[112:115], v[24:39]
  v_mfma_f32_32x32x16_bf16 v[40:55], v[120:123], v[108:111], v[40:55]
  v_mfma_f32_32x32x16_bf16 v[56:71], v[120:123], v[112:115], v[56:71]
  v_mfma_f32_32x32x16_bf16 v[72:87], v[124:127], v[108:111], v[72:87]
  s_setprio 3
  buffer_load_dwordx4 v[108:111], v3, s[8:11], s28 offen offset:1024
  buffer_load_dwordx4 v[112:115], v3, s[8:11], s29 offen offset:1024
  buffer_load_dwordx4 v[116:119], v5, s[8:11], s30 offen offset:1024
  buffer_load_dwordx4 v[120:123], v5, s[8:11], s31 offen offset:1024
  buffer_load_dwordx4 v[124:127], v5, s[8:11], s32 offen offset:1024
  s_waitcnt vmcnt(25)
  s_setprio 0
  v_mfma_f32_32x32x16_bf16 v[8:23], v[136:139], v[128:131], v[8:23]
  v_mfma_f32_32x32x16_bf16 v[24:39], v[136:139], v[132:135], v[24:39]
  v_mfma_f32_32x32x16_bf16 v[40:55], v[140:143], v[128:131], v[40:55]
  v_mfma_f32_32x32x16_bf16 v[56:71], v[140:143], v[132:135], v[56:71]
  v_mfma_f32_32x32x16_bf16 v[72:87], v[144:147], v[128:131], v[72:87]
  s_setprio 3
  buffer_load_dwordx4 v[128:131], v3, s[8:11], s28 offen offset:2048
  buffer_load_dwordx4 v[132:135], v3, s[8:11], s29 offen offset:2048
  buffer_load_dwordx4 v[136:139], v5, s[8:11], s30 offen offset:2048
  buffer_load_dwordx4 v[140:143], v5, s[8:11], s31 offen offset:2048
  buffer_load_dwordx4 v[144:147], v5, s[8:11], s32 offen offset:2048
  s_waitcnt vmcnt(25)
  s_setprio 0
  v_mfma_f32_32x32x16_bf16 v[8:23], v[156:159], v[148:151], v[8:23]
  v_mfma_f32_32x32x16_bf16 v[24:39], v[156:159], v[152:155], v[24:39]
  v_mfma_f32_32x32x16_bf16 v[40:55], v[160:163], v[148:151], v[40:55]
  v_mfma_f32_32x32x16_bf16 v[56:71], v[160:163], v[152:155], v[56:71]
  v_mfma_f32_32x32x16_bf16 v[72:87], v[164:167], v[148:151], v[72:87]
  s_setprio 3
  buffer_load_dwordx4 v[148:151], v3, s[8:11], s28 offen offset:3072
  buffer_load_dwordx4 v[152:155], v3, s[8:11], s29 offen offset:3072
  buffer_load_dwordx4 v[156:159], v5, s[8:11], s30 offen offset:3072
  buffer_load_dwordx4 v[160:163], v5, s[8:11], s31 offen offset:3072
  buffer_load_dwordx4 v[164:167], v5, s[8:11], s32 offen offset:3072
  s_waitcnt vmcnt(18)
  s_barrier
  s_add_u32 m0, s18, 0
  s_add_u32 s3, s17, 4096
  buffer_load_dwordx4 v3, s[8:11], s17 offen offset:0 lds
  buffer_load_dwordx4 v3, s[8:11], s17 offen offset:1024 lds
  buffer_load_dwordx4 v3, s[8:11], s17 offen offset:2048 lds
  buffer_load_dwordx4 v3, s[8:11], s17 offen offset:3072 lds
  s_add_u32 m0, s18, 4096
  s_add_u32 s17, s17, 21504
  buffer_load_dwordx4 v3, s[8:11], s3 offen offset:0 lds
  buffer_load_dwordx4 v3, s[8:11], s3 offen offset:1024 lds
  s_add_u32 m0, s61, 3072
  s_add_u32 s3, s57, 3072
  buffer_load_dwordx4 v5, s[8:11], s3 offen offset:0 lds
  s_add_u32 m0, s61, 10240
  s_add_u32 s3, s58, 3072
  buffer_load_dwordx4 v5, s[8:11], s3 offen offset:0 lds
  s_add_u32 m0, s61, 17408
  s_add_u32 s3, s59, 3072
  buffer_load_dwordx4 v5, s[8:11], s3 offen offset:0 lds
  s_setprio 0
  v_mfma_f32_32x32x16_bf16 v[8:23], v[96:99], v[88:91], v[8:23]
  v_mfma_f32_32x32x16_bf16 v[24:39], v[96:99], v[92:95], v[24:39]
  v_mfma_f32_32x32x16_bf16 v[40:55], v[100:103], v[88:91], v[40:55]
  v_mfma_f32_32x32x16_bf16 v[56:71], v[100:103], v[92:95], v[56:71]
  v_mfma_f32_32x32x16_bf16 v[72:87], v[104:107], v[88:91], v[72:87]
  s_setprio 3
  s_add_u32 s28, s28, 4096
  buffer_load_dwordx4 v[88:91], v3, s[8:11], s28 offen offset:0
  s_add_u32 s29, s29, 4096
  buffer_load_dwordx4 v[92:95], v3, s[8:11], s29 offen offset:0
  s_add_u32 s30, s30, 4096
  buffer_load_dwordx4 v[96:99], v5, s[8:11], s30 offen offset:0
  s_add_u32 s31, s31, 4096
  buffer_load_dwordx4 v[100:103], v5, s[8:11], s31 offen offset:0
  s_add_u32 s32, s32, 4096
  buffer_load_dwordx4 v[104:107], v5, s[8:11], s32 offen offset:0
  s_waitcnt vmcnt(24)
  s_setprio 0
  v_mfma_f32_32x32x16_bf16 v[8:23], v[116:119], v[108:111], v[8:23]
  v_mfma_f32_32x32x16_bf16 v[24:39], v[116:119], v[112:115], v[24:39]
  v_mfma_f32_32x32x16_bf16 v[40:55], v[120:123], v[108:111], v[40:55]
  v_mfma_f32_32x32x16_bf16 v[56:71], v[120:123], v[112:115], v[56:71]
  v_mfma_f32_32x32x16_bf16 v[72:87], v[124:127], v[108:111], v[72:87]
  s_setprio 3
  buffer_load_dwordx4 v[108:111], v3, s[8:11], s28 offen offset:1024
  buffer_load_dwordx4 v[112:115], v3, s[8:11], s29 offen offset:1024
  buffer_load_dwordx4 v[116:119], v5, s[8:11], s30 offen offset:1024
  buffer_load_dwordx4 v[120:123], v5, s[8:11], s31 offen offset:1024
  buffer_load_dwordx4 v[124:127], v5, s[8:11], s32 offen offset:1024
  s_waitcnt vmcnt(24)
  s_setprio 0
  v_mfma_f32_32x32x16_bf16 v[8:23], v[136:139], v[128:131], v[8:23]
  v_mfma_f32_32x32x16_bf16 v[24:39], v[136:139], v[132:135], v[24:39]
  v_mfma_f32_32x32x16_bf16 v[40:55], v[140:143], v[128:131], v[40:55]
  v_mfma_f32_32x32x16_bf16 v[56:71], v[140:143], v[132:135], v[56:71]
  v_mfma_f32_32x32x16_bf16 v[72:87], v[144:147], v[128:131], v[72:87]
  s_setprio 3
  buffer_load_dwordx4 v[128:131], v3, s[8:11], s28 offen offset:2048
  buffer_load_dwordx4 v[132:135], v3, s[8:11], s29 offen offset:2048
  buffer_load_dwordx4 v[136:139], v5, s[8:11], s30 offen offset:2048
  buffer_load_dwordx4 v[140:143], v5, s[8:11], s31 offen offset:2048
  buffer_load_dwordx4 v[144:147], v5, s[8:11], s32 offen offset:2048
  s_waitcnt vmcnt(18)
  s_barrier
  s_add_u32 m0, s18, 24576
  s_add_u32 s3, s17, 4096
  buffer_load_dwordx4 v3, s[8:11], s17 offen offset:0 lds
  buffer_load_dwordx4 v3, s[8:11], s17 offen offset:1024 lds
  buffer_load_dwordx4 v3, s[8:11], s17 offen offset:2048 lds
  buffer_load_dwordx4 v3, s[8:11], s17 offen offset:3072 lds
  s_add_u32 m0, s18, 28672
  s_add_u32 s17, s17, 21504
  buffer_load_dwordx4 v3, s[8:11], s3 offen offset:0 lds
  buffer_load_dwordx4 v3, s[8:11], s3 offen offset:1024 lds
  s_add_u32 m0, s61, 4096
  s_add_u32 s3, s57, 4096
  buffer_load_dwordx4 v5, s[8:11], s3 offen offset:0 lds
  s_add_u32 m0, s61, 11264
  s_add_u32 s3, s58, 4096
  buffer_load_dwordx4 v5, s[8:11], s3 offen offset:0 lds
  s_add_u32 m0, s61, 18432
  s_add_u32 s3, s59, 4096
  buffer_load_dwordx4 v5, s[8:11], s3 offen offset:0 lds
  s_setprio 0
  v_mfma_f32_32x32x16_bf16 v[8:23], v[156:159], v[148:151], v[8:23]
  v_mfma_f32_32x32x16_bf16 v[24:39], v[156:159], v[152:155], v[24:39]
  v_mfma_f32_32x32x16_bf16 v[40:55], v[160:163], v[148:151], v[40:55]
  v_mfma_f32_32x32x16_bf16 v[56:71], v[160:163], v[152:155], v[56:71]
  v_mfma_f32_32x32x16_bf16 v[72:87], v[164:167], v[148:151], v[72:87]
  s_setprio 3
  buffer_load_dwordx4 v[148:151], v3, s[8:11], s28 offen offset:3072
  buffer_load_dwordx4 v[152:155], v3, s[8:11], s29 offen offset:3072
  buffer_load_dwordx4 v[156:159], v5, s[8:11], s30 offen offset:3072
  buffer_load_dwordx4 v[160:163], v5, s[8:11], s31 offen offset:3072
  buffer_load_dwordx4 v[164:167], v5, s[8:11], s32 offen offset:3072
  s_waitcnt vmcnt(24)
  s_setprio 0
  v_mfma_f32_32x32x16_bf16 v[8:23], v[96:99], v[88:91], v[8:23]
  v_mfma_f32_32x32x16_bf16 v[24:39], v[96:99], v[92:95], v[24:39]
  v_mfma_f32_32x32x16_bf16 v[40:55], v[100:103], v[88:91], v[40:55]
  v_mfma_f32_32x32x16_bf16 v[56:71], v[100:103], v[92:95], v[56:71]
  v_mfma_f32_32x32x16_bf16 v[72:87], v[104:107], v[88:91], v[72:87]
  s_setprio 3
  s_add_u32 s28, s28, 4096
  buffer_load_dwordx4 v[88:91], v3, s[8:11], s28 offen offset:0
  s_add_u32 s29, s29, 4096
  buffer_load_dwordx4 v[92:95], v3, s[8:11], s29 offen offset:0
  s_add_u32 s30, s30, 4096
  buffer_load_dwordx4 v[96:99], v5, s[8:11], s30 offen offset:0
  s_add_u32 s31, s31, 4096
  buffer_load_dwordx4 v[100:103], v5, s[8:11], s31 offen offset:0
  s_add_u32 s32, s32, 4096
  buffer_load_dwordx4 v[104:107], v5, s[8:11], s32 offen offset:0
  s_waitcnt vmcnt(24)
  s_setprio 0
  v_mfma_f32_32x32x16_bf16 v[8:23], v[116:119], v[108:111], v[8:23]
  v_mfma_f32_32x32x16_bf16 v[24:39], v[116:119], v[112:115], v[24:39]
  v_mfma_f32_32x32x16_bf16 v[40:55], v[120:123], v[108:111], v[40:55]
  v_mfma_f32_32x32x16_bf16 v[56:71], v[120:123], v[112:115], v[56:71]
  v_mfma_f32_32x32x16_bf16 v[72:87], v[124:127], v[108:111], v[72:87]
  s_setprio 3
  buffer_load_dwordx4 v[108:111], v3, s[8:11], s28 offen offset:1024
  buffer_load_dwordx4 v[112:115], v3, s[8:11], s29 offen offset:1024
  buffer_load_dwordx4 v[116:119], v5, s[8:11], s30 offen offset:1024
  buffer_load_dwordx4 v[120:123], v5, s[8:11], s31 offen offset:1024
  buffer_load_dwordx4 v[124:127], v5, s[8:11], s32 offen offset:1024
  s_waitcnt vmcnt(18)
  s_barrier
  s_add_u32 m0, s18, 0
  s_add_u32 s3, s17, 4096
  buffer_load_dwordx4 v3, s[8:11], s17 offen offset:0 lds
  buffer_load_dwordx4 v3, s[8:11], s17 offen offset:1024 lds
  buffer_load_dwordx4 v3, s[8:11], s17 offen offset:2048 lds
  buffer_load_dwordx4 v3, s[8:11], s17 offen offset:3072 lds
  s_add_u32 m0, s18, 4096
  s_add_u32 s17, s17, 21504
  buffer_load_dwordx4 v3, s[8:11], s3 offen offset:0 lds
  buffer_load_dwordx4 v3, s[8:11], s3 offen offset:1024 lds
  s_add_u32 m0, s61, 5120
  s_add_u32 s3, s57, 5120
  buffer_load_dwordx4 v5, s[8:11], s3 offen offset:0 lds
  s_add_u32 m0, s61, 12288
  s_add_u32 s3, s58, 5120
  buffer_load_dwordx4 v5, s[8:11], s3 offen offset:0 lds
  s_add_u32 m0, s61, 19456
  s_add_u32 s3, s59, 5120
  buffer_load_dwordx4 v5, s[8:11], s3 offen offset:0 lds
  s_setprio 0
  v_mfma_f32_32x32x16_bf16 v[8:23], v[136:139], v[128:131], v[8:23]
  v_mfma_f32_32x32x16_bf16 v[24:39], v[136:139], v[132:135], v[24:39]
  v_mfma_f32_32x32x16_bf16 v[40:55], v[140:143], v[128:131], v[40:55]
  v_mfma_f32_32x32x16_bf16 v[56:71], v[140:143], v[132:135], v[56:71]
  v_mfma_f32_32x32x16_bf16 v[72:87], v[144:147], v[128:131], v[72:87]
  s_setprio 3
  buffer_load_dwordx4 v[128:131], v3, s[8:11], s28 offen offset:2048
  buffer_load_dwordx4 v[132:135], v3, s[8:11], s29 offen offset:2048
  buffer_load_dwordx4 v[136:139], v5, s[8:11], s30 offen offset:2048
  buffer_load_dwordx4 v[140:143], v5, s[8:11], s31 offen offset:2048
  buffer_load_dwordx4 v[144:147], v5, s[8:11], s32 offen offset:2048
  s_waitcnt vmcnt(24)
  s_setprio 0
  v_mfma_f32_32x32x16_bf16 v[8:23], v[156:159], v[148:151], v[8:23]
  v_mfma_f32_32x32x16_bf16 v[24:39], v[156:159], v[152:155], v[24:39]
  v_mfma_f32_32x32x16_bf16 v[40:55], v[160:163], v[148:151], v[40:55]
  v_mfma_f32_32x32x16_bf16 v[56:71], v[160:163], v[152:155], v[56:71]
  v_mfma_f32_32x32x16_bf16 v[72:87], v[164:167], v[148:151], v[72:87]
  s_setprio 3
  buffer_load_dwordx4 v[148:151], v3, s[8:11], s28 offen offset:3072
  buffer_load_dwordx4 v[152:155], v3, s[8:11], s29 offen offset:3072
  buffer_load_dwordx4 v[156:159], v5, s[8:11], s30 offen offset:3072
  buffer_load_dwordx4 v[160:163], v5, s[8:11], s31 offen offset:3072
  buffer_load_dwordx4 v[164:167], v5, s[8:11], s32 offen offset:3072
  s_waitcnt vmcnt(24)
  s_setprio 0
  v_mfma_f32_32x32x16_bf16 v[8:23], v[96:99], v[88:91], v[8:23]
  v_mfma_f32_32x32x16_bf16 v[24:39], v[96:99], v[92:95], v[24:39]
  v_mfma_f32_32x32x16_bf16 v[40:55], v[100:103], v[88:91], v[40:55]
  v_mfma_f32_32x32x16_bf16 v[56:71], v[100:103], v[92:95], v[56:71]
  v_mfma_f32_32x32x16_bf16 v[72:87], v[104:107], v[88:91], v[72:87]
  s_setprio 3
  s_add_u32 s28, s28, 4096
  buffer_load_dwordx4 v[88:91], v3, s[8:11], s28 offen offset:0
  s_add_u32 s29, s29, 4096
  buffer_load_dwordx4 v[92:95], v3, s[8:11], s29 offen offset:0
  s_add_u32 s30, s30, 4096
  buffer_load_dwordx4 v[96:99], v5, s[8:11], s30 offen offset:0
  s_add_u32 s31, s31, 4096
  buffer_load_dwordx4 v[100:103], v5, s[8:11], s31 offen offset:0
  s_add_u32 s32, s32, 4096
  buffer_load_dwordx4 v[104:107], v5, s[8:11], s32 offen offset:0
  s_waitcnt vmcnt(18)
  s_barrier
  s_add_u32 m0, s18, 24576
  s_add_u32 s3, s17, 4096
  buffer_load_dwordx4 v3, s[8:11], s17 offen offset:0 lds
  buffer_load_dwordx4 v3, s[8:11], s17 offen offset:1024 lds
  buffer_load_dwordx4 v3, s[8:11], s17 offen offset:2048 lds
  buffer_load_dwordx4 v3, s[8:11], s17 offen offset:3072 lds
  s_add_u32 m0, s18, 28672
  s_add_u32 s17, s17, 21504
  buffer_load_dwordx4 v3, s[8:11], s3 offen offset:0 lds
  buffer_load_dwordx4 v3, s[8:11], s3 offen offset:1024 lds
  s_add_u32 m0, s61, 6144
  s_add_u32 s3, s57, 6144
  buffer_load_dwordx4 v5, s[8:11], s3 offen offset:0 lds
  s_add_u32 m0, s61, 13312
  s_add_u32 s3, s58, 6144
  buffer_load_dwordx4 v5, s[8:11], s3 offen offset:0 lds
  s_add_u32 m0, s61, 20480
  s_add_u32 s3, s59, 6144
  buffer_load_dwordx4 v5, s[8:11], s3 offen offset:0 lds
  s_setprio 0
  v_mfma_f32_32x32x16_bf16 v[8:23], v[116:119], v[108:111], v[8:23]
  v_mfma_f32_32x32x16_bf16 v[24:39], v[116:119], v[112:115], v[24:39]
  v_mfma_f32_32x32x16_bf16 v[40:55], v[120:123], v[108:111], v[40:55]
  v_mfma_f32_32x32x16_bf16 v[56:71], v[120:123], v[112:115], v[56:71]
  v_mfma_f32_32x32x16_bf16 v[72:87], v[124:127], v[108:111], v[72:87]
  s_setprio 3
  buffer_load_dwordx4 v[108:111], v3, s[8:11], s28 offen offset:1024
  buffer_load_dwordx4 v[112:115], v3, s[8:11], s29 offen offset:1024
  buffer_load_dwordx4 v[116:119], v5, s[8:11], s30 offen offset:1024
  buffer_load_dwordx4 v[120:123], v5, s[8:11], s31 offen offset:1024
  buffer_load_dwordx4 v[124:127], v5, s[8:11], s32 offen offset:1024
  s_waitcnt vmcnt(24)
  s_setprio 0
  v_mfma_f32_32x32x16_bf16 v[8:23], v[136:139], v[128:131], v[8:23]
  v_mfma_f32_32x32x16_bf16 v[24:39], v[136:139], v[132:135], v[24:39]
  v_mfma_f32_32x32x16_bf16 v[40:55], v[140:143], v[128:131], v[40:55]
  v_mfma_f32_32x32x16_bf16 v[56:71], v[140:143], v[132:135], v[56:71]
  v_mfma_f32_32x32x16_bf16 v[72:87], v[144:147], v[128:131], v[72:87]
  s_setprio 3
  buffer_load_dwordx4 v[128:131], v3, s[8:11], s28 offen offset:2048
  buffer_load_dwordx4 v[132:135], v3, s[8:11], s29 offen offset:2048
  buffer_load_dwordx4 v[136:139], v5, s[8:11], s30 offen offset:2048
  buffer_load_dwordx4 v[140:143], v5, s[8:11], s31 offen offset:2048
  buffer_load_dwordx4 v[144:147], v5, s[8:11], s32 offen offset:2048
  s_waitcnt vmcnt(24)
  s_setprio 0
  v_mfma_f32_32x32x16_bf16 v[8:23], v[156:159], v[148:151], v[8:23]
  v_mfma_f32_32x32x16_bf16 v[24:39], v[156:159], v[152:155], v[24:39]
  v_mfma_f32_32x32x16_bf16 v[40:55], v[160:163], v[148:151], v[40:55]
  v_mfma_f32_32x32x16_bf16 v[56:71], v[160:163], v[152:155], v[56:71]
  v_mfma_f32_32x32x16_bf16 v[72:87], v[164:167], v[148:151], v[72:87]
  s_setprio 3
  buffer_load_dwordx4 v[148:151], v3, s[8:11], s28 offen offset:3072
  buffer_load_dwordx4 v[152:155], v3, s[8:11], s29 offen offset:3072
  buffer_load_dwordx4 v[156:159], v5, s[8:11], s30 offen offset:3072
  buffer_load_dwordx4 v[160:163], v5, s[8:11], s31 offen offset:3072
  buffer_load_dwordx4 v[164:167], v5, s[8:11], s32 offen offset:3072
  s_waitcnt vmcnt(18)
  s_barrier
  s_add_u32 m0, s18, 0
  s_add_u32 s3, s57, 7168
  buffer_load_dwordx4 v5, s[8:11], s3 offen offset:0 lds
  buffer_load_dwordx4 v5, s[8:11], s3 offen offset:1024 lds
  s_add_u32 m0, s18, 2048
  s_add_u32 s3, s58, 7168
  buffer_load_dwordx4 v5, s[8:11], s3 offen offset:0 lds
  buffer_load_dwordx4 v5, s[8:11], s3 offen offset:1024 lds
  s_add_u32 m0, s18, 4096
  s_add_u32 s3, s59, 7168
  buffer_load_dwordx4 v5, s[8:11], s3 offen offset:0 lds
  buffer_load_dwordx4 v5, s[8:11], s3 offen offset:1024 lds
  s_setprio 0
  v_mfma_f32_32x32x16_bf16 v[8:23], v[96:99], v[88:91], v[8:23]
  v_mfma_f32_32x32x16_bf16 v[24:39], v[96:99], v[92:95], v[24:39]
  v_mfma_f32_32x32x16_bf16 v[40:55], v[100:103], v[88:91], v[40:55]
  v_mfma_f32_32x32x16_bf16 v[56:71], v[100:103], v[92:95], v[56:71]
  v_mfma_f32_32x32x16_bf16 v[72:87], v[104:107], v[88:91], v[72:87]
  s_setprio 3
  s_add_u32 s28, s28, 4096
  buffer_load_dwordx4 v[88:91], v3, s[8:11], s28 offen offset:0
  s_add_u32 s29, s29, 4096
  buffer_load_dwordx4 v[92:95], v3, s[8:11], s29 offen offset:0
  s_add_u32 s30, s30, 4096
  buffer_load_dwordx4 v[96:99], v5, s[8:11], s30 offen offset:0
  s_add_u32 s31, s31, 4096
  buffer_load_dwordx4 v[100:103], v5, s[8:11], s31 offen offset:0
  s_add_u32 s32, s32, 4096
  buffer_load_dwordx4 v[104:107], v5, s[8:11], s32 offen offset:0
  s_waitcnt vmcnt(21)
  s_setprio 0
  v_mfma_f32_32x32x16_bf16 v[8:23], v[116:119], v[108:111], v[8:23]
  v_mfma_f32_32x32x16_bf16 v[24:39], v[116:119], v[112:115], v[24:39]
  v_mfma_f32_32x32x16_bf16 v[40:55], v[120:123], v[108:111], v[40:55]
  v_mfma_f32_32x32x16_bf16 v[56:71], v[120:123], v[112:115], v[56:71]
  v_mfma_f32_32x32x16_bf16 v[72:87], v[124:127], v[108:111], v[72:87]
  s_setprio 3
  buffer_load_dwordx4 v[108:111], v3, s[8:11], s28 offen offset:1024
  buffer_load_dwordx4 v[112:115], v3, s[8:11], s29 offen offset:1024
  buffer_load_dwordx4 v[116:119], v5, s[8:11], s30 offen offset:1024
  buffer_load_dwordx4 v[120:123], v5, s[8:11], s31 offen offset:1024
  buffer_load_dwordx4 v[124:127], v5, s[8:11], s32 offen offset:1024
  v_and_b32 v1, 15, v4
  v_lshlrev_b32 v1, 2, v1
  s_lshl_b32 s6, s13, 2
  s_lshl_b32 s6, 15, s6
  s_mov_b32 s63, 0
L_k2_kernel_arm:
  buffer_load_dword v7, v1, s[8:11], s62 offen sc0 sc1
  s_add_u32 s63, s63, 1
  s_waitcnt vmcnt(0)
  v_cmp_eq_u32 vcc, 0, v7
  s_and_b32 s3, vcc_lo, s6
  s_cmp_gt_u32 s63, 0x40000
  s_cselect_b32 s3, 0, s3
  s_cmp_eq_u32 s3, 0
  s_cbranch_scc0 L_k2_kernel_arm
  v_cmp_ne_u32 vcc, s38, v7
  v_mov_b32 v1, 0
  s_cmp_eq_u32 vcc_lo, 0
  s_cselect_b32 s3, 1, 0
  v_mov_b32 v7, s3
  s_cmp_lg_u32 s13, 0
  s_cbranch_scc1 L_k2_kernel_nosame
  ds_write_b32 v1, v7 offset:49184
  s_waitcnt lgkmcnt(0)
L_k2_kernel_nosame:
  s_barrier
  s_setprio 0
  v_mfma_f32_32x32x16_bf16 v[8:23], v[136:139], v[128:131], v[8:23]
  v_mfma_f32_32x32x16_bf16 v[24:39], v[136:139], v[132:135], v[24:39]
  v_mfma_f32_32x32x16_bf16 v[40:55], v[140:143], v[128:131], v[40:55]
  v_mfma_f32_32x32x16_bf16 v[56:71], v[140:143], v[132:135], v[56:71]
  v_mfma_f32_32x32x16_bf16 v[72:87], v[144:147], v[128:131], v[72:87]
  s_setprio 3
  buffer_load_dwordx4 v[128:131], v3, s[8:11], s28 offen offset:2048
  buffer_load_dwordx4 v[132:135], v3, s[8:11], s29 offen offset:2048
  buffer_load_dwordx4 v[136:139], v5, s[8:11], s30 offen offset:2048
  buffer_load_dwordx4 v[140:143], v5, s[8:11], s31 offen offset:2048
  buffer_load_dwordx4 v[144:147], v5, s[8:11], s32 offen offset:2048
  s_barrier
  s_setprio 0
  v_mfma_f32_32x32x16_bf16 v[8:23], v[156:159], v[148:151], v[8:23]
  v_mfma_f32_32x32x16_bf16 v[24:39], v[156:159], v[152:155], v[24:39]
  v_mfma_f32_32x32x16_bf16 v[40:55], v[160:163], v[148:151], v[40:55]
  v_mfma_f32_32x32x16_bf16 v[56:71], v[160:163], v[152:155], v[56:71]
  v_mfma_f32_32x32x16_bf16 v[72:87], v[164:167], v[148:151], v[72:87]
  s_setprio 3
  s_sub_u32 s28, s28, s33
  s_add_u32 s28, s28, 86016
  s_sub_u32 s29, s29, s33
  s_add_u32 s29, s29, 86016
  s_add_u32 s3, s57, 9216
  buffer_load_dwordx4 v[152:155], v5, s[8:11], s3 offen
  s_add_u32 s3, s58, 9216
  buffer_load_dwordx4 v[156:159], v5, s[8:11], s3 offen
  s_add_u32 s3, s59, 9216
  buffer_load_dwordx4 v[160:163], v5, s[8:11], s3 offen
  s_setprio 0
  v_mfma_f32_32x32x16_bf16 v[8:23], v[96:99], v[88:91], v[8:23]
  v_mfma_f32_32x32x16_bf16 v[24:39], v[96:99], v[92:95], v[24:39]
  v_mfma_f32_32x32x16_bf16 v[40:55], v[100:103], v[88:91], v[40:55]
  v_mfma_f32_32x32x16_bf16 v[56:71], v[100:103], v[92:95], v[56:71]
  v_mfma_f32_32x32x16_bf16 v[72:87], v[104:107], v[88:91], v[72:87]
  s_setprio 3
  s_setprio 0
  v_mfma_f32_32x32x16_bf16 v[8:23], v[116:119], v[108:111], v[8:23]
  v_mfma_f32_32x32x16_bf16 v[24:39], v[116:119], v[112:115], v[24:39]
  v_mfma_f32_32x32x16_bf16 v[40:55], v[120:123], v[108:111], v[40:55]
  v_mfma_f32_32x32x16_bf16 v[56:71], v[120:123], v[112:115], v[56:71]
  v_mfma_f32_32x32x16_bf16 v[72:87], v[124:127], v[108:111], v[72:87]
  s_setprio 3
  s_waitcnt vmcnt(3)
  s_setprio 0
  v_mfma_f32_32x32x16_bf16 v[8:23], v[136:139], v[128:131], v[8:23]
  v_mfma_f32_32x32x16_bf16 v[24:39], v[136:139], v[132:135], v[24:39]
  v_mfma_f32_32x32x16_bf16 v[40:55], v[140:143], v[128:131], v[40:55]
  v_mfma_f32_32x32x16_bf16 v[56:71], v[140:143], v[132:135], v[56:71]
  v_mfma_f32_32x32x16_bf16 v[72:87], v[144:147], v[128:131], v[72:87]
  s_setprio 3
  s_branch L_k2_kernel_gpub
L_k2_kernel_gmerge:
  s_barrier
L_k2_kernel_gpub:
  v_mov_b32 v1, 0
  s_barrier
  ds_read_b128 v[88:91], v1 offset:49152
  ds_read_b128 v[92:95], v1 offset:49168
  s_waitcnt lgkmcnt(0)
  v_or3_b32 v88, v88, v89, v90
  v_or3_b32 v88, v88, v91, v92
  v_or3_b32 v88, v88, v93, v94
  v_or_b32 v88, v88, v95
  s_nop 1
  v_readfirstlane_b32 s3, v88
  s_nop 1
  s_cmp_lg_u32 s3, 0
  s_cbranch_scc1 L_k2_kernel_gexact
  v_add_u32 v1, s61, v3
  v_add_u32 v5, s18, v3
  s_add_u32 s6, s28, 4096
  s_add_u32 s7, s29, 4096
  s_add_u32 s34, s28, 8192
  s_add_u32 s35, s29, 8192
  s_mul_i32 s3, s13, 3072
  s_add_u32 m0, s3, 36864
  ds_read_b128 v[136:139], v1 offset:0
  ds_read_b128 v[140:143], v1 offset:7168
  ds_read_b128 v[144:147], v1 offset:14336
  ds_read_b128 v[148:151], v1 offset:1024
L_k2_kernel_try:
  buffer_load_dwordx4 v[88:91], v3, s[8:11], s28 offen offset:0 sc0 sc1
  buffer_load_dwordx4 v[92:95], v3, s[8:11], s29 offen offset:0 sc0 sc1
  buffer_load_dwordx4 v[96:99], v3, s[8:11], s28 offen offset:1024 sc0 sc1
  buffer_load_dwordx4 v[100:103], v3, s[8:11], s29 offen offset:1024 sc0 sc1
  buffer_load_dwordx4 v[104:107], v3, s[8:11], s28 offen offset:2048 sc0 sc1
  buffer_load_dwordx4 v[108:111], v3, s[8:11], s29 offen offset:2048 sc0 sc1
  s_waitcnt vmcnt(4)
L_k2_kernel_chk0:
  v_max3_u32 v7, v88, v90, v92
  v_max_u32 v7, v7, v94
  v_cmp_eq_u32 vcc, -1, v7
  s_cbranch_vccnz L_k2_kernel_rl0
L_k2_kernel_ok0:
  s_waitcnt lgkmcnt(3)
  v_mfma_f32_32x32x16_bf16 v[8:23], v[136:139], v[88:91], v[8:23]
  v_mfma_f32_32x32x16_bf16 v[24:39], v[136:139], v[92:95], v[24:39]
  ds_read_b128 v[136:139], v1 offset:8192
  buffer_load_dwordx4 v[112:115], v3, s[8:11], s28 offen offset:3072 sc0 sc1
  buffer_load_dwordx4 v[116:119], v3, s[8:11], s29 offen offset:3072 sc0 sc1
  s_waitcnt lgkmcnt(3)
  v_mfma_f32_32x32x16_bf16 v[40:55], v[140:143], v[88:91], v[40:55]
  v_mfma_f32_32x32x16_bf16 v[56:71], v[140:143], v[92:95], v[56:71]
  ds_read_b128 v[140:143], v1 offset:15360
  s_waitcnt vmcnt(4)
L_k2_kernel_chk1:
  v_max3_u32 v7, v96, v98, v100
  v_max_u32 v7, v7, v102
  v_cmp_eq_u32 vcc, -1, v7
  s_cbranch_vccnz L_k2_kernel_rl1
L_k2_kernel_ok1:
  s_waitcnt lgkmcnt(3)
  v_mfma_f32_32x32x16_bf16 v[72:87], v[144:147], v[88:91], v[72:87]
  ds_read_b128 v[144:147], v1 offset:2048
  buffer_load_dwordx4 v[120:123], v3, s[8:11], s6 offen offset:0 sc0 sc1
  buffer_load_dwordx4 v[124:127], v3, s[8:11], s7 offen offset:0 sc0 sc1
  s_waitcnt lgkmcnt(3)
  v_mfma_f32_32x32x16_bf16 v[8:23], v[148:151], v[96:99], v[8:23]
  v_mfma_f32_32x32x16_bf16 v[24:39], v[148:151], v[100:103], v[24:39]
  ds_read_b128 v[148:151], v1 offset:9216
  buffer_load_dwordx4 v[128:131], v3, s[8:11], s6 offen offset:1024 sc0 sc1
  buffer_load_dwordx4 v[132:135], v3, s[8:11], s7 offen offset:1024 sc0 sc1
  s_waitcnt lgkmcnt(3)
  v_mfma_f32_32x32x16_bf16 v[40:55], v[136:139], v[96:99], v[40:55]
  v_mfma_f32_32x32x16_bf16 v[56:71], v[136:139], v[100:103], v[56:71]
  ds_read_b128 v[136:139], v1 offset:16384
  s_waitcnt vmcnt(6)
L_k2_kernel_chk2:
  v_max3_u32 v7, v104, v106, v108
  v_max_u32 v7, v7, v110
  v_cmp_eq_u32 vcc, -1, v7
  s_cbranch_vccnz L_k2_kernel_rl2
L_k2_kernel_ok2:
  s_waitcnt lgkmcnt(3)
  v_mfma_f32_32x32x16_bf16 v[72:87], v[140:143], v[96:99], v[72:87]
  ds_read_b128 v[140:143], v1 offset:3072
  buffer_load_dwordx4 v[88:91], v3, s[8:11], s6 offen offset:2048 sc0 sc1
  buffer_load_dwordx4 v[92:95], v3, s[8:11], s7 offen offset:2048 sc0 sc1
  s_waitcnt lgkmcnt(3)
  v_mfma_f32_32x32x16_bf16 v[8:23], v[144:147], v[104:107], v[8:23]
  v_mfma_f32_32x32x16_bf16 v[24:39], v[144:147], v[108:111], v[24:39]
  ds_read_b128 v[144:147], v1 offset:10240
  buffer_load_dwordx4 v[96:99], v3, s[8:11], s6 offen offset:3072 sc0 sc1
  buffer_load_dwordx4 v[100:103], v3, s[8:11], s7 offen offset:3072 sc0 sc1
  s_waitcnt lgkmcnt(3)
  v_mfma_f32_32x32x16_bf16 v[40:55], v[148:151], v[104:107], v[40:55]
  v_mfma_f32_32x32x16_bf16 v[56:71], v[148:151], v[108:111], v[56:71]
  ds_read_b128 v[148:151], v1 offset:17408
  s_waitcnt vmcnt(8)
L_k2_kernel_chk3:
  v_max3_u32 v7, v112, v114, v116
  v_max_u32 v7, v7, v118
  v_cmp_eq_u32 vcc, -1, v7
  s_cbranch_vccnz L_k2_kernel_rl3
L_k2_kernel_ok3:
  s_waitcnt lgkmcnt(3)
  v_mfma_f32_32x32x16_bf16 v[72:87], v[136:139], v[104:107], v[72:87]
  ds_read_b128 v[136:139], v1 offset:4096
  buffer_load_dwordx4 v[104:107], v3, s[8:11], s34 offen offset:0 sc0 sc1
  buffer_load_dwordx4 v[108:111], v3, s[8:11], s35 offen offset:0 sc0 sc1
  s_waitcnt lgkmcnt(3)
  v_mfma_f32_32x32x16_bf16 v[8:23], v[140:143], v[112:115], v[8:23]
  v_mfma_f32_32x32x16_bf16 v[24:39], v[140:143], v[116:119], v[24:39]
  ds_read_b128 v[140:143], v1 offset:11264
  s_waitcnt lgkmcnt(3)
  v_mfma_f32_32x32x16_bf16 v[40:55], v[144:147], v[112:115], v[40:55]
  v_mfma_f32_32x32x16_bf16 v[56:71], v[144:147], v[116:119], v[56:71]
  ds_read_b128 v[144:147], v1 offset:18432
  s_waitcnt vmcnt(8)
L_k2_kernel_chk4:
  v_max3_u32 v7, v120, v122, v124
  v_max_u32 v7, v7, v126
  v_cmp_eq_u32 vcc, -1, v7
  s_cbranch_vccnz L_k2_kernel_rl4
L_k2_kernel_ok4:
  s_waitcnt lgkmcnt(3)
  v_mfma_f32_32x32x16_bf16 v[72:87], v[148:151], v[112:115], v[72:87]
  ds_read_b128 v[148:151], v1 offset:5120
  buffer_load_dwordx4 v[112:115], v3, s[8:11], s34 offen offset:1024 sc0 sc1
  buffer_load_dwordx4 v[116:119], v3, s[8:11], s35 offen offset:1024 sc0 sc1
  s_waitcnt lgkmcnt(3)
  v_mfma_f32_32x32x16_bf16 v[8:23], v[136:139], v[120:123], v[8:23]
  v_mfma_f32_32x32x16_bf16 v[24:39], v[136:139], v[124:127], v[24:39]
  ds_read_b128 v[136:139], v1 offset:12288
  s_waitcnt lgkmcnt(3)
  v_mfma_f32_32x32x16_bf16 v[40:55], v[140:143], v[120:123], v[40:55]
  v_mfma_f32_32x32x16_bf16 v[56:71], v[140:143], v[124:127], v[56:71]
  ds_read_b128 v[140:143], v1 offset:19456
  s_waitcnt vmcnt(8)
L_k2_kernel_chk5:
  v_max3_u32 v7, v128, v130, v132
  v_max_u32 v7, v7, v134
  v_cmp_eq_u32 vcc, -1, v7
  s_cbranch_vccnz L_k2_kernel_rl5
L_k2_kernel_ok5:
  s_waitcnt lgkmcnt(3)
  v_mfma_f32_32x32x16_bf16 v[72:87], v[144:147], v[120:123], v[72:87]
  ds_read_b128 v[144:147], v1 offset:6144
  s_waitcnt lgkmcnt(3)
  v_mfma_f32_32x32x16_bf16 v[8:23], v[148:151], v[128:131], v[8:23]
  v_mfma_f32_32x32x16_bf16 v[24:39], v[148:151], v[132:135], v[24:39]
  ds_read_b128 v[148:151], v1 offset:13312
  buffer_load_dwordx4 v0, s[44:47], s56 offen lds
  s_add_u32 m0, m0, 1024
  s_waitcnt lgkmcnt(3)
  v_mfma_f32_32x32x16_bf16 v[40:55], v[136:139], v[128:131], v[40:55]
  v_mfma_f32_32x32x16_bf16 v[56:71], v[136:139], v[132:135], v[56:71]
  ds_read_b128 v[136:139], v1 offset:20480
  buffer_load_dwordx4 v6, s[44:47], s56 offen lds
  s_add_u32 m0, m0, 1024
  s_waitcnt vmcnt(8)
L_k2_kernel_chk6:
  v_max3_u32 v7, v88, v90, v92
  v_max_u32 v7, v7, v94
  v_cmp_eq_u32 vcc, -1, v7
  s_cbranch_vccnz L_k2_kernel_rl6
L_k2_kernel_ok6:
  s_waitcnt lgkmcnt(3)
  v_mfma_f32_32x32x16_bf16 v[72:87], v[140:143], v[128:131], v[72:87]
  ds_read_b128 v[140:143], v5 offset:0
  buffer_load_dwordx4 v2, s[44:47], s56 offen lds
  s_add_u32 m0, m0, 1024
  s_waitcnt lgkmcnt(3)
  v_mfma_f32_32x32x16_bf16 v[8:23], v[144:147], v[88:91], v[8:23]
  v_mfma_f32_32x32x16_bf16 v[24:39], v[144:147], v[92:95], v[24:39]
  ds_read_b128 v[144:147], v5 offset:1024
  s_waitcnt lgkmcnt(3)
  v_mfma_f32_32x32x16_bf16 v[40:55], v[148:151], v[88:91], v[40:55]
  v_mfma_f32_32x32x16_bf16 v[56:71], v[148:151], v[92:95], v[56:71]
  s_waitcnt vmcnt(7)
L_k2_kernel_chk7:
  v_max3_u32 v7, v96, v98, v100
  v_max_u32 v7, v7, v102
  v_cmp_eq_u32 vcc, -1, v7
  s_cbranch_vccnz L_k2_kernel_rl7
L_k2_kernel_ok7:
  s_waitcnt lgkmcnt(2)
  v_mfma_f32_32x32x16_bf16 v[72:87], v[136:139], v[88:91], v[72:87]
  ds_read_b128 v[136:139], v5 offset:2048
  s_waitcnt lgkmcnt(2)
  v_mfma_f32_32x32x16_bf16 v[8:23], v[140:143], v[96:99], v[8:23]
  v_mfma_f32_32x32x16_bf16 v[24:39], v[140:143], v[100:103], v[24:39]
  ds_read_b128 v[140:143], v5 offset:3072
  s_waitcnt vmcnt(5)
L_k2_kernel_chk8:
  v_max3_u32 v7, v104, v106, v108
  v_max_u32 v7, v7, v110
  v_cmp_eq_u32 vcc, -1, v7
  s_cbranch_vccnz L_k2_kernel_rl8
L_k2_kernel_ok8:
  s_waitcnt lgkmcnt(2)
  v_mfma_f32_32x32x16_bf16 v[8:23], v[144:147], v[104:107], v[8:23]
  v_mfma_f32_32x32x16_bf16 v[24:39], v[144:147], v[108:111], v[24:39]
  s_waitcnt vmcnt(3)
L_k2_kernel_chk9:
  v_max3_u32 v7, v112, v114, v116
  v_max_u32 v7, v7, v118
  v_cmp_eq_u32 vcc, -1, v7
  s_cbranch_vccnz L_k2_kernel_rl9
L_k2_kernel_ok9:
  v_mfma_f32_32x32x16_bf16 v[8:23], v[152:155], v[112:115], v[8:23]
  v_mfma_f32_32x32x16_bf16 v[24:39], v[152:155], v[116:119], v[24:39]
  ds_read_b128 v[148:151], v5 offset:4096
  s_waitcnt lgkmcnt(2)
  v_mfma_f32_32x32x16_bf16 v[40:55], v[136:139], v[96:99], v[40:55]
  v_mfma_f32_32x32x16_bf16 v[56:71], v[136:139], v[100:103], v[56:71]
  ds_read_b128 v[136:139], v5 offset:5120
  s_nop 7
  s_waitcnt lgkmcnt(2)
  v_mfma_f32_32x32x16_bf16 v[40:55], v[140:143], v[104:107], v[40:55]
  ds_write_b128 v1, v[12:15] offset:0
  ds_write_b128 v1, v[16:19] offset:5120
  v_mfma_f32_32x32x16_bf16 v[56:71], v[140:143], v[108:111], v[56:71]
  ds_write_b128 v1, v[20:23] offset:10240
  ds_write_b128 v1, v[28:31] offset:1024
  v_mfma_f32_32x32x16_bf16 v[40:55], v[156:159], v[112:115], v[40:55]
  v_mfma_f32_32x32x16_bf16 v[56:71], v[156:159], v[116:119], v[56:71]
  ds_write_b128 v1, v[32:35] offset:6144
  ds_write_b128 v1, v[36:39] offset:11264
  s_waitcnt lgkmcnt(7)
  v_mfma_f32_32x32x16_bf16 v[72:87], v[148:151], v[96:99], v[72:87]
  s_waitcnt lgkmcnt(6)
  v_mfma_f32_32x32x16_bf16 v[72:87], v[136:139], v[104:107], v[72:87]
  v_mfma_f32_32x32x16_bf16 v[72:87], v[160:163], v[112:115], v[72:87]
  s_sub_u32 s3, s13, 1
  s_and_b32 s3, s3, 3
  s_mul_i32 s3, s3, 21504
  s_add_u32 s3, s3, 76800
  v_add_u32 v88, s3, v3
  s_sub_u32 s3, s13, 2
  s_and_b32 s3, s3, 3
  s_mul_i32 s3, s3, 21504
  s_add_u32 s3, s3, 81920
  v_add_u32 v89, s3, v3
  s_sub_u32 s3, s13, 3
  s_and_b32 s3, s3, 3
  s_mul_i32 s3, s3, 21504
  s_add_u32 s3, s3, 87040
  v_add_u32 v90, s3, v3
  ds_write_b128 v1, v[44:47] offset:2048
  ds_write_b128 v1, v[48:51] offset:7168
  ds_write_b128 v1, v[52:55] offset:12288
  ds_write_b128 v1, v[60:63] offset:3072
  ds_write_b128 v1, v[64:67] offset:8192
  ds_write_b128 v1, v[68:71] offset:13312
  ds_write_b128 v1, v[76:79] offset:4096
  ds_write_b128 v1, v[80:83] offset:9216
  ds_write_b128 v1, v[84:87] offset:14336
  v_and_b32 v91, 31, v4
  v_mul_u32_u24 v91, 192, v91
  v_lshrrev_b32 v7, 5, v4
  v_lshl_add_u32 v91, v7, 3, v91
  v_bfe_u32 v7, v4, 2, 2
  v_xor_b32 v7, s13, v7
  v_lshl_add_u32 v91, v7, 4, v91
  s_mul_i32 s3, s13, 3072
  v_add_u32 v5, s3, v3
  s_waitcnt vmcnt(0) lgkmcnt(0)
  s_barrier
  ds_read_b64 v[96:97], v91 offset:36864
  ds_read_b128 v[12:15], v88 offset:0
  ds_read_b128 v[16:19], v89 offset:0
  ds_read_b128 v[20:23], v90 offset:0
  ds_read_b64 v[98:99], v91 offset:43008
  ds_read_b128 v[28:31], v88 offset:1024
  ds_read_b128 v[32:35], v89 offset:1024
  ds_read_b128 v[36:39], v90 offset:1024
  ds_read_b64 v[100:101], v91 offset:36928
  ds_read_b128 v[44:47], v88 offset:2048
  ds_read_b128 v[48:51], v89 offset:2048
  ds_read_b128 v[52:55], v90 offset:2048
  ds_read_b64 v[102:103], v91 offset:43072
  ds_read_b128 v[60:63], v88 offset:3072
  ds_read_b128 v[64:67], v89 offset:3072
  ds_read_b128 v[68:71], v90 offset:3072
  ds_read_b64 v[104:105], v91 offset:36992
  ds_read_b128 v[76:79], v88 offset:4096
  ds_read_b128 v[80:83], v89 offset:4096
  ds_read_b128 v[84:87], v90 offset:4096
  s_waitcnt lgkmcnt(15)
  v_pk_add_f32 v[8:9], v[8:9], v[12:13]
  v_pk_add_f32 v[10:11], v[10:11], v[14:15]
  v_pk_add_f32 v[16:17], v[16:17], v[20:21]
  v_pk_add_f32 v[18:19], v[18:19], v[22:23]
  v_lshlrev_b32 v12, 16, v96
  v_and_b32 v13, 0xffff0000, v96
  v_lshlrev_b32 v14, 16, v97
  v_and_b32 v15, 0xffff0000, v97
  v_pk_add_f32 v[8:9], v[8:9], v[16:17]
  v_pk_add_f32 v[10:11], v[10:11], v[18:19]
  v_pk_add_f32 v[8:9], v[8:9], v[12:13]
  v_pk_add_f32 v[10:11], v[10:11], v[14:15]
  v_cvt_pk_bf16_f32 v8, v8, v9
  v_cvt_pk_bf16_f32 v9, v10, v11
  ds_write_b64 v91, v[8:9] offset:24576
  s_waitcnt lgkmcnt(13)
  v_pk_add_f32 v[24:25], v[24:25], v[28:29]
  v_pk_add_f32 v[26:27], v[26:27], v[30:31]
  v_pk_add_f32 v[32:33], v[32:33], v[36:37]
  v_pk_add_f32 v[34:35], v[34:35], v[38:39]
  v_lshlrev_b32 v28, 16, v98
  v_and_b32 v29, 0xffff0000, v98
  v_lshlrev_b32 v30, 16, v99
  v_and_b32 v31, 0xffff0000, v99
  v_pk_add_f32 v[24:25], v[24:25], v[32:33]
  v_pk_add_f32 v[26:27], v[26:27], v[34:35]
  v_pk_add_f32 v[24:25], v[24:25], v[28:29]
  v_pk_add_f32 v[26:27], v[26:27], v[30:31]
  v_cvt_pk_bf16_f32 v24, v24, v25
  v_cvt_pk_bf16_f32 v25, v26, v27
  ds_write_b64 v91, v[24:25] offset:30720
  s_waitcnt lgkmcnt(10)
  v_pk_add_f32 v[40:41], v[40:41], v[44:45]
  v_pk_add_f32 v[42:43], v[42:43], v[46:47]
  v_pk_add_f32 v[48:49], v[48:49], v[52:53]
  v_pk_add_f32 v[50:51], v[50:51], v[54:55]
  v_lshlrev_b32 v44, 16, v100
  v_and_b32 v45, 0xffff0000, v100
  v_lshlrev_b32 v46, 16, v101
  v_and_b32 v47, 0xffff0000, v101
  v_pk_add_f32 v[40:41], v[40:41], v[48:49]
  v_pk_add_f32 v[42:43], v[42:43], v[50:51]
  v_pk_add_f32 v[40:41], v[40:41], v[44:45]
  v_pk_add_f32 v[42:43], v[42:43], v[46:47]
  v_cvt_pk_bf16_f32 v40, v40, v41
  v_cvt_pk_bf16_f32 v41, v42, v43
  ds_write_b64 v91, v[40:41] offset:24640
  s_waitcnt lgkmcnt(7)
  v_pk_add_f32 v[56:57], v[56:57], v[60:61]
  v_pk_add_f32 v[58:59], v[58:59], v[62:63]
  v_pk_add_f32 v[64:65], v[64:65], v[68:69]
  v_pk_add_f32 v[66:67], v[66:67], v[70:71]
  v_lshlrev_b32 v60, 16, v102
  v_and_b32 v61, 0xffff0000, v102
  v_lshlrev_b32 v62, 16, v103
  v_and_b32 v63, 0xffff0000, v103
  v_pk_add_f32 v[56:57], v[56:57], v[64:65]
  v_pk_add_f32 v[58:59], v[58:59], v[66:67]
  v_pk_add_f32 v[56:57], v[56:57], v[60:61]
  v_pk_add_f32 v[58:59], v[58:59], v[62:63]
  v_cvt_pk_bf16_f32 v56, v56, v57
  v_cvt_pk_bf16_f32 v57, v58, v59
  ds_write_b64 v91, v[56:57] offset:30784
  s_waitcnt lgkmcnt(4)
  v_pk_add_f32 v[72:73], v[72:73], v[76:77]
  v_pk_add_f32 v[74:75], v[74:75], v[78:79]
  v_pk_add_f32 v[80:81], v[80:81], v[84:85]
  v_pk_add_f32 v[82:83], v[82:83], v[86:87]
  v_lshlrev_b32 v76, 16, v104
  v_and_b32 v77, 0xffff0000, v104
  v_lshlrev_b32 v78, 16, v105
  v_and_b32 v79, 0xffff0000, v105
  v_pk_add_f32 v[72:73], v[72:73], v[80:81]
  v_pk_add_f32 v[74:75], v[74:75], v[82:83]
  v_pk_add_f32 v[72:73], v[72:73], v[76:77]
  v_pk_add_f32 v[74:75], v[74:75], v[78:79]
  v_cvt_pk_bf16_f32 v72, v72, v73
  v_cvt_pk_bf16_f32 v73, v74, v75
  ds_write_b64 v91, v[72:73] offset:24704
  s_waitcnt lgkmcnt(0)
  s_barrier
  ds_read_b128 v[8:11], v5 offset:24576
  ds_read_b128 v[12:15], v5 offset:25600
  ds_read_b128 v[16:19], v5 offset:26624
  s_waitcnt lgkmcnt(2)
  buffer_store_dwordx4 v[8:11], v0, s[52:55], s56 offen sc0 sc1
  s_waitcnt lgkmcnt(1)
  buffer_store_dwordx4 v[12:15], v6, s[52:55], s56 offen sc0 sc1
  s_waitcnt lgkmcnt(0)
  buffer_store_dwordx4 v[16:19], v2, s[52:55], s56 offen sc0 sc1
  s_branch L_k2_kernel_fin
L_k2_kernel_rl0:
  s_add_u32 s33, s33, 1
  s_cmp_gt_u32 s33, 0x80000
  s_cbranch_scc1 L_k2_kernel_ok0
  s_waitcnt vmcnt(0)
  s_sleep 2
  s_branch L_k2_kernel_try
L_k2_kernel_rl1:
  s_add_u32 s33, s33, 1
  s_cmp_gt_u32 s33, 0x80000
  s_cbranch_scc1 L_k2_kernel_ok1
  buffer_load_dwordx4 v[96:99], v3, s[8:11], s28 offen offset:1024 sc0 sc1
  buffer_load_dwordx4 v[100:103], v3, s[8:11], s29 offen offset:1024 sc0 sc1
  s_waitcnt vmcnt(0)
  s_branch L_k2_kernel_chk1
L_k2_kernel_rl2:
  s_add_u32 s33, s33, 1
  s_cmp_gt_u32 s33, 0x80000
  s_cbranch_scc1 L_k2_kernel_ok2
  buffer_load_dwordx4 v[104:107], v3, s[8:11], s28 offen offset:2048 sc0 sc1
  buffer_load_dwordx4 v[108:111], v3, s[8:11], s29 offen offset:2048 sc0 sc1
  s_waitcnt vmcnt(0)
  s_branch L_k2_kernel_chk2
L_k2_kernel_rl3:
  s_add_u32 s33, s33, 1
  s_cmp_gt_u32 s33, 0x80000
  s_cbranch_scc1 L_k2_kernel_ok3
  buffer_load_dwordx4 v[112:115], v3, s[8:11], s28 offen offset:3072 sc0 sc1
  buffer_load_dwordx4 v[116:119], v3, s[8:11], s29 offen offset:3072 sc0 sc1
  s_waitcnt vmcnt(0)
  s_branch L_k2_kernel_chk3
L_k2_kernel_rl4:
  s_add_u32 s33, s33, 1
  s_cmp_gt_u32 s33, 0x80000
  s_cbranch_scc1 L_k2_kernel_ok4
  buffer_load_dwordx4 v[120:123], v3, s[8:11], s6 offen offset:0 sc0 sc1
  buffer_load_dwordx4 v[124:127], v3, s[8:11], s7 offen offset:0 sc0 sc1
  s_waitcnt vmcnt(0)
  s_branch L_k2_kernel_chk4
L_k2_kernel_rl5:
  s_add_u32 s33, s33, 1
  s_cmp_gt_u32 s33, 0x80000
  s_cbranch_scc1 L_k2_kernel_ok5
  buffer_load_dwordx4 v[128:131], v3, s[8:11], s6 offen offset:1024 sc0 sc1
  buffer_load_dwordx4 v[132:135], v3, s[8:11], s7 offen offset:1024 sc0 sc1
  s_waitcnt vmcnt(0)
  s_branch L_k2_kernel_chk5
L_k2_kernel_rl6:
  s_add_u32 s33, s33, 1
  s_cmp_gt_u32 s33, 0x80000
  s_cbranch_scc1 L_k2_kernel_ok6
  buffer_load_dwordx4 v[88:91], v3, s[8:11], s6 offen offset:2048 sc0 sc1
  buffer_load_dwordx4 v[92:95], v3, s[8:11], s7 offen offset:2048 sc0 sc1
  s_waitcnt vmcnt(0)
  s_branch L_k2_kernel_chk6
L_k2_kernel_rl7:
  s_add_u32 s33, s33, 1
  s_cmp_gt_u32 s33, 0x80000
  s_cbranch_scc1 L_k2_kernel_ok7
  buffer_load_dwordx4 v[96:99], v3, s[8:11], s6 offen offset:3072 sc0 sc1
  buffer_load_dwordx4 v[100:103], v3, s[8:11], s7 offen offset:3072 sc0 sc1
  s_waitcnt vmcnt(0)
  s_branch L_k2_kernel_chk7
L_k2_kernel_rl8:
  s_add_u32 s33, s33, 1
  s_cmp_gt_u32 s33, 0x80000
  s_cbranch_scc1 L_k2_kernel_ok8
  buffer_load_dwordx4 v[104:107], v3, s[8:11], s34 offen offset:0 sc0 sc1
  buffer_load_dwordx4 v[108:111], v3, s[8:11], s35 offen offset:0 sc0 sc1
  s_waitcnt vmcnt(0)
  s_branch L_k2_kernel_chk8
L_k2_kernel_rl9:
  s_add_u32 s33, s33, 1
  s_cmp_gt_u32 s33, 0x80000
  s_cbranch_scc1 L_k2_kernel_ok9
  buffer_load_dwordx4 v[112:115], v3, s[8:11], s34 offen offset:1024 sc0 sc1
  buffer_load_dwordx4 v[116:119], v3, s[8:11], s35 offen offset:1024 sc0 sc1
  s_waitcnt vmcnt(0)
  s_branch L_k2_kernel_chk9
L_k2_kernel_gexact:
  s_mov_b32 s19, 1
  s_mov_b32 s20, 0
  s_add_u32 s17, s18, 2621440
L_k2_kernel_gex1:
  s_barrier
  s_add_u32 m0, s18, 0
  s_add_u32 s3, s17, 4096
  buffer_load_dwordx4 v3, s[8:11], s17 offen offset:0 lds
  buffer_load_dwordx4 v3, s[8:11], s17 offen offset:1024 lds
  buffer_load_dwordx4 v3, s[8:11], s17 offen offset:2048 lds
  buffer_load_dwordx4 v3, s[8:11], s17 offen offset:3072 lds
  s_add_u32 m0, s18, 4096
  s_add_u32 s17, s17, 21504
  buffer_load_dwordx4 v3, s[8:11], s3 offen offset:0 lds
  buffer_load_dwordx4 v3, s[8:11], s3 offen offset:1024 lds
  s_waitcnt vmcnt(0)
  s_barrier
  s_add_u32 s20, s20, 1
  s_cmp_lt_u32 s20, 8
  s_cbranch_scc1 L_k2_kernel_gex1
  s_barrier
  s_add_u32 s17, s18, 2621440
  s_add_u32 m0, s18, 0
  s_add_u32 s3, s17, 4096
  buffer_load_dwordx4 v3, s[8:11], s17 offen offset:0 lds
  buffer_load_dwordx4 v3, s[8:11], s17 offen offset:1024 lds
  buffer_load_dwordx4 v3, s[8:11], s17 offen offset:2048 lds
  buffer_load_dwordx4 v3, s[8:11], s17 offen offset:3072 lds
  s_add_u32 m0, s18, 4096
  s_add_u32 s17, s17, 21504
  buffer_load_dwordx4 v3, s[8:11], s3 offen offset:0 lds
  buffer_load_dwordx4 v3, s[8:11], s3 offen offset:1024 lds
  s_add_u32 m0, s18, 24576
  s_add_u32 s3, s17, 4096
  buffer_load_dwordx4 v3, s[8:11], s17 offen offset:0 lds
  buffer_load_dwordx4 v3, s[8:11], s17 offen offset:1024 lds
  buffer_load_dwordx4 v3, s[8:11], s17 offen offset:2048 lds
  buffer_load_dwordx4 v3, s[8:11], s17 offen offset:3072 lds
  s_add_u32 m0, s18, 28672
  s_add_u32 s17, s17, 21504
  buffer_load_dwordx4 v3, s[8:11], s3 offen offset:0 lds
  buffer_load_dwordx4 v3, s[8:11], s3 offen offset:1024 lds
  s_waitcnt vmcnt(0)
  s_barrier
  s_mov_b32 s20, 0
L_k2_kernel_gex2:
  s_waitcnt vmcnt(0)
  s_barrier
  s_cmp_eq_u32 s20, 3
  s_cbranch_scc1 L_k2_kernel_gex3_0
  s_add_u32 m0, s18, 0
  s_add_u32 s3, s17, 4096
  buffer_load_dwordx4 v3, s[8:11], s17 offen offset:0 lds
  buffer_load_dwordx4 v3, s[8:11], s17 offen offset:1024 lds
  buffer_load_dwordx4 v3, s[8:11], s17 offen offset:2048 lds
  buffer_load_dwordx4 v3, s[8:11], s17 offen offset:3072 lds
  s_add_u32 m0, s18, 4096
  s_add_u32 s17, s17, 21504
  buffer_load_dwordx4 v3, s[8:11], s3 offen offset:0 lds
  buffer_load_dwordx4 v3, s[8:11], s3 offen offset:1024 lds
L_k2_kernel_gex3_0:
  s_waitcnt vmcnt(0)
  s_barrier
  s_cmp_eq_u32 s20, 3
  s_cbranch_scc1 L_k2_kernel_gex3_1
  s_add_u32 m0, s18, 24576
  s_add_u32 s3, s17, 4096
  buffer_load_dwordx4 v3, s[8:11], s17 offen offset:0 lds
  buffer_load_dwordx4 v3, s[8:11], s17 offen offset:1024 lds
  buffer_load_dwordx4 v3, s[8:11], s17 offen offset:2048 lds
  buffer_load_dwordx4 v3, s[8:11], s17 offen offset:3072 lds
  s_add_u32 m0, s18, 28672
  s_add_u32 s17, s17, 21504
  buffer_load_dwordx4 v3, s[8:11], s3 offen offset:0 lds
  buffer_load_dwordx4 v3, s[8:11], s3 offen offset:1024 lds
L_k2_kernel_gex3_1:
  s_add_u32 s20, s20, 1
  s_cmp_lt_u32 s20, 4
  s_cbranch_scc1 L_k2_kernel_gex2
  s_add_u32 m0, s18, 0
  s_add_u32 s3, s57, 7168
  buffer_load_dwordx4 v5, s[8:11], s3 offen offset:0 lds
  buffer_load_dwordx4 v5, s[8:11], s3 offen offset:1024 lds
  s_add_u32 m0, s18, 2048
  s_add_u32 s3, s58, 7168
  buffer_load_dwordx4 v5, s[8:11], s3 offen offset:0 lds
  buffer_load_dwordx4 v5, s[8:11], s3 offen offset:1024 lds
  s_add_u32 m0, s18, 4096
  s_add_u32 s3, s59, 7168
  buffer_load_dwordx4 v5, s[8:11], s3 offen offset:0 lds
  buffer_load_dwordx4 v5, s[8:11], s3 offen offset:1024 lds
  s_branch L_k2_kernel_gmerge
L_k2_kernel_fin:
L_k2_kernel_end:
  s_endpgm
.section .rodata,"a"
.p2align 6
.amdhsa_kernel k2_kernel
  .amdhsa_next_free_vgpr 168
  .amdhsa_next_free_sgpr 96
  .amdhsa_accum_offset 168
  .amdhsa_group_segment_fixed_size 0
  .amdhsa_kernarg_size 104
  .amdhsa_user_sgpr_count 2
  .amdhsa_user_sgpr_kernarg_segment_ptr 1
  .amdhsa_system_sgpr_workgroup_id_x 1
.end_amdhsa_kernel
.text
L_code_end:
```
